```python
import torch

def _softmax(x, axis=-1):
    return torch.softmax(x, dim=axis)
def _gelu(x):
    return torch.nn.functional.gelu(x, approximate="tanh")
def _silu(x):
    return torch.nn.functional.silu(x)
def _sigmoid(x):
    return torch.sigmoid(x)
def _layernorm(x, axis=-1, eps=1e-5):
    m = x.mean(dim=axis, keepdim=True)
    v = x.var(dim=axis, keepdim=True, unbiased=False)
    return (x - m) / torch.sqrt(v + eps)
def _scatter_add(tgt, idx, src, axis=0):
    return tgt.clone().index_add_(axis, idx, src)
def _segment_sum(src, seg, n):
    out = torch.zeros((n,) + src.shape[1:], dtype=src.dtype)
    return out.index_add_(0, seg, src)
def _pad(x, pw):
    flat = tuple(v for pair in reversed(pw) for v in pair)
    return torch.nn.functional.pad(x, flat)

kernel_name = 'sequential_preLN__linear_attn_block__dense_activation_squared_relu__prompt'

def setup_inputs():

    _w = (lambda a: (lambda t: t.to(torch.bfloat16) if t.is_floating_point() else t)(torch.as_tensor(a)))
    def _A_setup():
        B, S, D = 1, 2048, 448
        return {
            "x": _w((lambda *s: torch.randn(*s, dtype=torch.bfloat16) * 0.05)(B, S, D)),
            "wqkv": _w((lambda *s: torch.randn(*s, dtype=torch.bfloat16) * 0.1)(D, 3 * D)),
            "wo": _w((lambda *s: torch.randn(*s, dtype=torch.bfloat16) * 0.05)(D, D)),
        }
    _A_in = _A_setup()

    def _B_setup():
        B, S, D, F = 1, 2048, 448, 1792
        return {
            "x": _w((lambda *s: torch.randn(*s, dtype=torch.bfloat16) * 0.05)(B, S, D)),
            "w1": _w((lambda *s: torch.randn(*s, dtype=torch.bfloat16) * 0.05)(D, F)),
            "b1": _w((lambda *s: torch.randn(*s, dtype=torch.bfloat16) * 0.2)(F)),
            "w2": _w((lambda *s: torch.randn(*s, dtype=torch.bfloat16) * 0.05)(F, D)),
            "b2": _w((lambda *s: torch.randn(*s, dtype=torch.bfloat16) * 0.8)(D)),
        }
    _B_in = _B_setup()

    return {
        "A_x": _A_in["x"],
        "A_wqkv": _A_in["wqkv"],
        "A_wo": _A_in["wo"],
        "B_x": _B_in["x"],
        "B_w1": _B_in["w1"],
        "B_b1": _B_in["b1"],
        "B_w2": _B_in["w2"],
        "B_b2": _B_in["b2"],
    }

def reference(A_x, A_wqkv, A_wo, B_x, B_w1, B_b1, B_w2, B_b2):
    def _A_ref(x, wqkv, wo):
        B, S, D = x.shape
        H = 16; Dh = D // H
        qkv = (lambda x, *d: x.permute(*d))((x @ wqkv).reshape(B, S, 3, H, Dh), 2, 0, 3, 1, 4)
        q, k, v = qkv[0], qkv[1], qkv[2]
        phi = lambda t: torch.where(t > 0, t + 1, torch.exp(t)) + 1e-6
        pq, pk = phi(q), phi(k)
        kv = torch.einsum("bhsd,bhse->bhde", pk, v)
        z = torch.einsum("bhsd->bhd", pk)
        num = torch.einsum("bhqd,bhde->bhqe", pq, kv)
        den = torch.einsum("bhqd,bhd->bhq", pq, z)[..., None] + 1e-6
        o = num / den
        return (lambda x, *d: x.permute(*d))(o, 0, 2, 1, 3).reshape(B, S, D) @ wo

    def _B_ref(x, w1, b1, w2, b2):
        h = torch.einsum("bsd,df->bsf", x, w1) + b1
        zero = torch.zeros_like(h)
        r = torch.where(h > zero, h, zero)
        h = r * r
        out = torch.einsum("bsf,fd->bsd", h, w2) + b2
        return out

    x = A_x
    h = x + _A_ref(_layernorm(x, axis=-1), A_wqkv, A_wo)
    h2 = h + _B_ref(_layernorm(h, axis=-1), B_w1, B_b1, B_w2, B_b2)
    return h2
```

```asm
; @launch grid=(256,1,1) block=(256,1,1) lds=163840
.amdgcn_target "amdgcn-amd-amdhsa--gfx950"
.text
.globl sequential_preLN__linear_attn_block__dense_activation_squared_relu__prompt_kernel
.p2align 8
.type sequential_preLN__linear_attn_block__dense_activation_squared_relu__prompt_kernel,@function
.set CODE_LIMIT, ((L_code_end - sequential_preLN__linear_attn_block__dense_activation_squared_relu__prompt_kernel - 128) & 0xfffffffc)
sequential_preLN__linear_attn_block__dense_activation_squared_relu__prompt_kernel:
    s_cmp_ge_u32 s2, 0x100
    s_cbranch_scc1 L_exit
    s_load_dwordx2 s[8:9], s[0:1], 0
    s_load_dwordx2 s[12:13], s[0:1], 8
    s_load_dwordx2 s[32:33], s[0:1], 80
    s_load_dwordx2 s[16:17], s[0:1], 16
    s_load_dwordx2 s[20:21], s[0:1], 32
    s_load_dwordx2 s[36:37], s[0:1], 40
    s_load_dwordx2 s[24:25], s[0:1], 48
    s_load_dwordx2 s[40:41], s[0:1], 56
    s_load_dwordx2 s[28:29], s[0:1], 64
    s_and_b32 s4, s2, 7
    s_lshr_b32 s5, s2, 3
    s_getpc_b64 s[44:45]
    s_lshl_b32 s52, s5, 10
    v_lshl_add_u32 v2, v0, 2, s52
    v_min_u32 v2, CODE_LIMIT, v2
    global_load_dword v110, v2, s[44:45]
    v_and_b32 v1, 63, v0
    v_lshrrev_b32 v2, 6, v0
    s_lshr_b32 s52, s5, 4
    v_readfirstlane_b32 s6, v2
    s_lshl_b32 s88, s4, 1
    s_add_u32 s88, s88, s52
    s_lshl_b32 s89, s52, 1
    s_add_u32 s89, s89, s5
    s_and_b32 s89, s89, 15
    s_add_u32 s61, s89, 1
    s_lshr_b32 s61, s61, 1
    s_add_u32 s61, s61, s88
    s_mul_i32 s52, s61, 37
    s_lshr_b32 s52, s52, 8
    s_mul_i32 s52, s52, 7
    s_sub_u32 s61, s61, s52
    s_lshl_b32 s54, s88, 2
    s_add_u32 s54, s54, s6
    s_mul_i32 s62, s54, 28672
    s_mul_i32 s63, s89, 56
    s_mul_i32 s64, s6, 12288
    s_lshl_b32 s65, s6, 10
    s_mov_b32 s10, 1835008
    s_mov_b32 s11, 0x20000
    s_mov_b32 s14, 1204224
    s_mov_b32 s15, 0x20000
    s_mov_b32 s34, 11534336
    s_mov_b32 s35, 0x20000
    v_lshrrev_b32 v80, 2, v0
    v_mul_u32_u24 v80, 2688, v80
    v_and_b32 v81, 3, v0
    v_lshlrev_b32 v82, 4, v81
    v_min_u32 v83, 40, v82
    v_add_u32 v6, v80, v83
    v_lshrrev_b32 v81, 1, v81
    v_lshlrev_b32 v81, 2, v81
    v_sub_u32 v82, v82, v81
    v_add_u32 v80, 896, v80
    v_add_u32 v7, v80, v82
    v_lshrrev_b32 v80, 3, v1
    v_mul_u32_u24 v80, 896, v80
    v_lshrrev_b32 v81, 4, v1
    v_and_b32 v82, 7, v1
    v_xor_b32 v81, v81, v82
    v_lshl_add_u32 v2, v81, 4, v80
    v_xor_b32 v81, 4, v81
    v_lshl_add_u32 v3, v81, 4, v80
    v_add_u32 v3, 6144, v3
    v_add_u32 v4, 12288, v2
    v_add_u32 v5, 12288, v3
    s_mul_i32 s53, s61, 172032
    s_lshl_b32 s52, s61, 7
    s_add_u32 s53, s53, s63
    s_add_u32 s52, s52, s62
    s_waitcnt lgkmcnt(0)
    s_add_u32 m0, s65, 48256
    s_add_u32 s61, s61, 1
    buffer_load_dwordx4 v6, s[12:15], s53 offen offset:896 lds
    s_add_u32 m0, s65, 76928
    s_cmp_eq_u32 s61, 7
    buffer_load_dwordx4 v7, s[12:15], s53 offen offset:896 lds
    s_cselect_b32 s61, 0, s61
    s_add_u32 m0, s64, 0
    s_nop 0
    buffer_load_dwordx4 v2, s[8:11], s52 offen lds
    buffer_load_dwordx4 v3, s[8:11], s52 offen offset:1024 lds
    buffer_load_dwordx4 v4, s[8:11], s52 offen offset:2048 lds
    buffer_load_dwordx4 v5, s[8:11], s52 offen offset:3072 lds
    s_load_dword s59, s[32:33], 0
    v_lshrrev_b32 v112, 5, v1
    v_bfe_u32 v113, v1, 2, 2
    v_bfe_u32 v114, v1, 4, 1
    v_and_b32 v115, 3, v1
    v_lshl_add_u32 v80, v112, 3, v113
    v_lshlrev_b32 v80, 6, v80
    v_lshl_add_u32 v81, v114, 2, v115
    v_cmp_le_u32 vcc, 6, v81
    s_nop 1
    v_cndmask_b32_e64 v82, 0, 1, vcc
    v_xor_b32 v82, v82, v81
    v_lshl_add_u32 v82, v82, 3, v80
    v_add_u32 v8, 49152, v82
    v_add_u32 v10, 114688, v82
    v_and_b32 v82, 1, v81
    v_lshrrev_b32 v81, 1, v81
    v_lshl_add_u32 v80, v82, 5, v80
    v_lshl_add_u32 v80, v81, 3, v80
    v_add_u32 v9, 77824, v80
    v_and_b32 v80, 31, v1
    v_bfe_u32 v81, v1, 1, 3
    v_xor_b32 v81, v81, v112
    v_lshl_add_u32 v80, v80, 7, s64
    v_xor_b32 v82, 0, v81
    v_lshl_add_u32 v11, v82, 4, v80
    v_xor_b32 v82, 2, v81
    v_lshl_add_u32 v12, v82, 4, v80
    v_xor_b32 v82, 4, v81
    v_lshl_add_u32 v13, v82, 4, v80
    v_xor_b32 v82, 6, v81
    v_lshl_add_u32 v14, v82, 4, v80
    v_xor_b32 v80, v113, v114
    v_and_b32 v80, 1, v80
    v_cmp_eq_u32 vcc, 0, v80
    v_mov_b32 v81, 0x3f803f80
    s_nop 0
    v_cndmask_b32 v16, 0, v81, vcc
    v_cndmask_b32 v17, 0, v81, vcc
    v_cndmask_b32 v18, 0, v81, vcc
    v_cndmask_b32 v19, 0, v81, vcc
    v_mov_b32 v120, 0
    v_mov_b32 v121, 0
    v_mov_b32 v122, 0
    v_mov_b32 v123, 0
    s_lshl_b32 s67, s89, 12
    s_add_u32 s67, s67, 65536
    s_cmp_eq_u32 s88, s89
    s_cselect_b32 s3, s67, 1073741824
    v_lshl_add_u32 v119, v0, 4, s3
    s_add_u32 s67, s67, s65
    s_mov_b32 s18, 401408
    s_mov_b32 s19, 0x20000
    s_mov_b32 s22, 1605632
    s_mov_b32 s23, 0x20000
    s_mov_b32 s26, 1605632
    s_mov_b32 s27, 0x20000
    s_mov_b32 s30, 1835008
    s_mov_b32 s31, 0x20000
    s_mov_b32 s38, 3584
    s_mov_b32 s39, 0x20000
    s_mov_b32 s42, 896
    s_mov_b32 s43, 0x20000
    s_getreg_b32 s60, hwreg(HW_REG_XCC_ID)
    s_and_b32 s60, s60, 7
    s_mov_b32 s58, 0x3f317218
    s_mov_b32 s48, -1
    s_mov_b32 s49, 0
    s_mov_b32 s50, 3154116607
    s_mov_b32 s51, 3154116607
    v_mov_b32 v136, 0x3f803f80
    v_mov_b32 v137, 0x3f803f80
    v_mov_b32 v138, 0x3f803f80
    v_mov_b32 v139, 0x3f803f80
    v_mov_b32 v140, 0x3f803f80
    v_mov_b32 v141, 0x3f803f80
    v_mov_b32 v142, 0x3f803f80
    v_mov_b32 v143, 0x3f803f80
    v_mov_b32 v89, 0
    v_mov_b32 v90, 0
    v_mov_b32 v91, 0
    v_mov_b32 v93, 0
    v_mov_b32 v94, 0
    v_mov_b32 v95, 0
    v_mov_b32 v97, 0
    v_mov_b32 v98, 0
    v_mov_b32 v99, 0
    s_lshl_b32 s55, s4, 7
    s_add_u32 s55, s55, 4096
    v_lshl_add_u32 v101, v1, 2, s55
    s_lshl_b32 s66, s89, 7
    s_add_u32 s66, s66, 8192
    v_mov_b32 v81, s66
    v_accvgpr_write_b32 a202, v101
    v_mov_b32 v101, v81
    s_lshl_b32 s3, s6, 8
    s_add_u32 s3, s3, s88
    s_cmp_eq_u32 s3, s89
    s_cselect_b32 s66, s66, 1073741824
    s_lshl_b32 s3, s5, 2
    s_add_u32 s55, s55, s3
    s_cmp_eq_u32 s6, 0
    s_cselect_b32 s55, s55, 1073741824
    v_lshlrev_b32 v84, 2, v0
    v_add_u32 v84, 159744, v84
    s_lshl_b32 s3, s6, 8
    s_add_u32 s3, s3, 159744
    v_lshl_add_u32 v85, v112, 4, s3
    s_lshl_b32 s3, s6, 12
    s_add_u32 s3, s3, 143360
    v_lshl_add_u32 v86, v1, 4, s3
    s_add_u32 s3, s65, 143360
    v_lshl_add_u32 v87, v1, 2, s3
    s_bitcmp1_b32 43604, s89
    s_cselect_b64 s[0:1], -1, 0
    s_lshl_b32 s74, s89, 7
    s_add_u32 s74, s74, 36864
    s_lshl_b32 s3, s88, 2
    s_add_u32 s68, s74, s3
    s_cmp_eq_u32 s6, 0
    s_cselect_b32 s68, s68, 1073741824
    s_lshl_b32 s3, s4, 11
    s_add_u32 s74, s74, s3
    s_mul_i32 s69, s54, 114688
    s_lshl_b32 s3, s89, 11
    s_add_u32 s69, s69, s3
    s_add_u32 s69, s69, 4194304
    s_lshl_b32 s70, s54, 4
    s_add_u32 s70, s70, s89
    s_lshl_b32 s70, s70, 2
    s_add_u32 s70, s70, 20480
    s_cmp_ge_u32 s5, 14
    s_cselect_b32 s44, 1, 0
    s_mul_i32 s3, s44, 14
    s_sub_u32 s45, s5, s3
    s_sub_u32 s45, s45, s44
    s_cselect_b32 s45, 13, s45
    s_lshl_b32 s56, s4, 1
    s_add_u32 s56, s56, s44
    s_cmp_ge_u32 s45, 7
    s_cselect_b32 s46, 1, 0
    s_mul_i32 s3, s46, 7
    s_sub_u32 s47, s45, s3
    s_lshl_b32 s54, s47, 1
    s_and_b32 s3, s6, 1
    s_add_u32 s54, s54, s3
    s_lshl_b32 s54, s54, 6
    s_lshl_b32 s57, s56, 1
    s_add_u32 s57, s57, s46
    s_lshl_b32 s75, s57, 7
    s_lshl_b32 s57, s57, 1
    s_lshr_b32 s3, s6, 1
    s_add_u32 s57, s57, s3
    v_lshlrev_b32 v80, 3, v112
    v_add_u32 v128, s54, v80
    v_and_b32 v81, 31, v1
    v_lshlrev_b32 v82, 1, v81
    s_lshl_b32 s73, s45, 8
    v_add_u32 v129, s73, v82
    v_mul_u32_u24 v81, 896, v81
    v_add_u32 v81, v81, v80
    v_accvgpr_write_b32 a198, v81
    s_mul_i32 s78, s57, 28672
    s_add_u32 s78, s78, s54
    s_mul_i32 s80, s57, 114688
    s_lshl_b32 s3, s54, 5
    s_add_u32 s80, s80, s3
    s_add_u32 s80, s80, 4280320
    s_lshl_b32 s81, s57, 12
    s_lshl_b32 s3, s54, 2
    s_add_u32 s81, s81, s3
    s_add_u32 s81, s81, 131072
    s_lshl_b32 s82, s57, 6
    s_lshr_b32 s3, s54, 4
    s_add_u32 s82, s82, s3
    s_add_u32 s82, s82, 24576
    s_mul_i32 s76, s57, 114688
    s_add_u32 s76, s76, 4194304
    s_xor_b32 s3, s57, 1
    s_mul_i32 s77, s3, 114688
    s_add_u32 s77, s77, 4194304
    s_and_b32 s3, s57, 3
    s_mul_i32 s3, s3, 12288
    s_add_u32 s3, s3, 125440
    v_lshl_add_u32 v81, v1, 2, s3
    v_accvgpr_write_b32 a201, v81
    s_lshl_b32 s84, s56, 2
    s_add_u32 s84, s84, s6
    s_mul_i32 s87, s84, 114688
    s_lshl_b32 s3, s45, 11
    s_add_u32 s87, s87, s3
    s_add_u32 s87, s87, 4194304
    s_mul_i32 s85, s84, 114688
    s_add_u32 s85, s85, 4280320
    s_lshl_b32 s88, s84, 4
    s_add_u32 s88, s88, s45
    s_lshl_b32 s88, s88, 2
    s_add_u32 s88, s88, 28672
    s_mul_i32 s89, s6, 7
    s_lshr_b32 s89, s89, 1
    s_lshl_b32 s89, s89, 2
    s_add_u32 s89, s89, s75
    s_add_u32 s89, s89, 28672
    s_lshl_b32 s3, s6, 5
    s_add_u32 s75, s75, s3
    s_add_u32 s75, s75, 20480
    s_and_b32 s79, s6, 1
    s_add_u32 s83, s64, 114688
    s_mul_i32 s72, s6, 14336
    s_add_u32 s72, s72, 57344
    s_mul_i32 s71, s6, 100352
    s_lshl_b32 s54, s47, 7
    s_add_u32 s71, s71, s54
    s_cmp_ge_u32 s5, 28
    s_cselect_b32 s71, 1073741824, s71
    s_cselect_b32 s80, 1073741824, s80
    s_cselect_b32 s81, 1073741824, s81
    v_lshlrev_b32 v80, 2, v114
    v_and_b32 v81, 7, v1
    v_xor_b32 v81, v81, v80
    v_lshrrev_b32 v80, 3, v1
    v_mul_u32_u24 v80, 896, v80
    v_lshl_add_u32 v80, v81, 4, v80
    v_accvgpr_write_b32 a195, v80
    v_lshrrev_b32 v80, 3, v0
    v_mul_u32_u24 v80, 3584, v80
    v_lshl_add_u32 v80, v81, 4, v80
    v_accvgpr_write_b32 a192, v80
    v_lshl_add_u32 v80, v112, 2, v113
    v_lshlrev_b32 v81, 5, v114
    v_lshl_add_u32 v81, v115, 3, v81
    v_lshl_add_u32 v82, v80, 7, v81
    v_lshrrev_b32 v80, 1, v113
    s_and_b32 s3, s6, 1
    v_xor_b32 v80, s3, v80
    v_lshl_add_u32 v82, v80, 6, v82
    v_accvgpr_write_b32 a196, v82
    v_xor_b32 v80, v80, v112
    v_mul_u32_u24 v82, 14, v112
    v_add_u32 v82, v82, v113
    v_lshl_add_u32 v82, v82, 7, v81
    v_lshl_add_u32 v82, v80, 6, v82
    s_mul_i32 s3, s79, 25088
    s_add_u32 s3, s3, 60928
    v_add_u32 v82, s3, v82
    v_accvgpr_write_b32 a193, v82
    v_and_b32 v80, 2, v113
    v_lshlrev_b32 v80, 8, v80
    v_sub_u32 v82, v82, v80
    v_accvgpr_write_b32 a194, v82
    v_and_b32 v80, 1, v113
    v_lshl_add_u32 v80, v80, 4, v115
    v_lshlrev_b32 v80, 2, v80
    v_accvgpr_write_b32 a199, v80
    s_xor_b32 s3, s6, 1
    s_mul_i32 s3, s3, 12288
    s_add_u32 s3, s3, 57344
    v_lshl_add_u32 v80, v1, 4, s3
    v_accvgpr_write_b32 a204, v80
    s_xor_b32 s3, s6, 2
    s_mul_i32 s3, s3, 12288
    s_add_u32 s3, s3, 61440
    v_lshl_add_u32 v80, v1, 4, s3
    v_accvgpr_write_b32 a205, v80
    s_xor_b32 s3, s6, 3
    s_mul_i32 s3, s3, 12288
    s_add_u32 s3, s3, 65536
    v_lshl_add_u32 v80, v1, 4, s3
    v_accvgpr_write_b32 a206, v80
    s_xor_b32 s3, s6, 0
    s_mul_i32 s3, s3, 12288
    s_add_u32 s3, s3, 57344
    v_lshl_add_u32 v80, v1, 4, s3
    v_accvgpr_write_b32 a207, v80
    v_min_u32 v80, 23, v1
    v_lshrrev_b32 v81, 2, v80
    v_and_b32 v80, 3, v80
    v_lshlrev_b32 v81, 12, v81
    v_lshl_add_u32 v80, v80, 7, v81
    s_lshl_b32 s3, s4, 9
    v_add_u32 v80, s3, v80
    v_and_b32 v81, 15, v1
    s_lshl_b32 s3, s4, 11
    s_add_u32 s3, s3, 24576
    v_lshl_add_u32 v81, v81, 7, s3
    v_cndmask_b32_e64 v80, v81, v80, s[48:49]
    s_lshl_b32 s3, s5, 2
    s_add_u32 s3, s3, s6
    s_cmp_eq_u32 s3, 112
    s_cselect_b32 s3, 0x3000, 1073741824
    v_add_u32 v15, s3, v80
    s_waitcnt lgkmcnt(0)
    s_add_u32 s59, s59, 0x9e3779b8
    s_and_b32 s7, s59, -8
    v_mov_b32 v100, s7
    s_or_b32 s60, s7, s60
    v_mov_b32 v118, s60
    s_lshr_b32 s57, s57, 1
    s_and_b32 s57, s57, 3
    s_mul_i32 s57, s57, 0
    s_add_u32 s57, s57, s47
    s_mul_i32 s53, s61, 172032
    s_lshl_b32 s52, s61, 7
    s_add_u32 s53, s53, s63
    s_add_u32 s52, s52, s62
    s_add_u32 m0, s65, 52352
    s_add_u32 s61, s61, 1
    buffer_load_dwordx4 v6, s[12:15], s53 offen offset:896 lds
    s_add_u32 m0, s65, 81024
    s_cmp_eq_u32 s61, 7
    buffer_load_dwordx4 v7, s[12:15], s53 offen offset:896 lds
    s_cselect_b32 s61, 0, s61
    s_add_u32 m0, s64, 4096
    s_nop 0
    buffer_load_dwordx4 v2, s[8:11], s52 offen lds
    buffer_load_dwordx4 v3, s[8:11], s52 offen offset:1024 lds
    buffer_load_dwordx4 v4, s[8:11], s52 offen offset:2048 lds
    buffer_load_dwordx4 v5, s[8:11], s52 offen offset:3072 lds
    s_waitcnt vmcnt(6)
    s_barrier
    v_add_u32 v125, s65, v8
    v_add_u32 v126, s65, v9
    ds_read_b128 v[144:147], v11 offset:0
    ds_read_b64_tr_b16 a[0:1], v8 offset:0
    ds_read_b64_tr_b16 a[2:3], v8 offset:256
    ds_read_b64_tr_b16 a[4:5], v9 offset:0
    ds_read_b64_tr_b16 a[6:7], v9 offset:256
    ds_read_b128 v[148:151], v12 offset:0
    ds_read_b64_tr_b16 a[8:9], v8 offset:1024
    ds_read_b64_tr_b16 a[10:11], v8 offset:1280
    ds_read_b64_tr_b16 a[12:13], v9 offset:1024
    ds_read_b64_tr_b16 a[14:15], v9 offset:1280
    s_waitcnt lgkmcnt(7)
    v_mfma_f32_32x32x16_bf16 v[32:47], v[144:147], a[0:3], 0
    ds_read_b64_tr_b16 a[64:65], v125 offset:0
    ds_read_b64_tr_b16 a[66:67], v125 offset:256
    ds_read_b64_tr_b16 a[68:69], v126 offset:0
    ds_read_b64_tr_b16 a[70:71], v126 offset:256
    ds_read_b128 v[152:155], v13 offset:0
    s_waitcnt lgkmcnt(10)
    v_mfma_f32_32x32x16_bf16 v[48:63], v[144:147], a[4:7], 0
    ds_read_b64_tr_b16 a[16:17], v8 offset:2048
    s_mul_i32 s53, s61, 172032
    s_lshl_b32 s52, s61, 7
    s_add_u32 s53, s53, s63
    s_add_u32 s52, s52, s62
    ds_read_b64_tr_b16 a[18:19], v8 offset:2304
    s_add_u32 m0, s65, 56448
    s_add_u32 s61, s61, 1
    buffer_load_dwordx4 v6, s[12:15], s53 offen offset:896 lds
    v_mfma_f32_16x16x32_bf16 v[20:23], v[16:19], v[144:147], 0
    ds_read_b64_tr_b16 a[20:21], v9 offset:2048
    s_waitcnt lgkmcnt(10)
    v_mfma_f32_32x32x16_bf16 v[32:47], v[148:151], a[8:11], v[32:47]
    ds_read_b64_tr_b16 a[22:23], v9 offset:2304
    s_add_u32 m0, s65, 85120
    s_cmp_eq_u32 s61, 7
    buffer_load_dwordx4 v7, s[12:15], s53 offen offset:896 lds
    s_cselect_b32 s61, 0, s61
    ds_read_b128 v[156:159], v14 offset:0
    s_add_u32 m0, s64, 8192
    s_nop 0
    buffer_load_dwordx4 v2, s[8:11], s52 offen lds
    s_waitcnt lgkmcnt(8)
    v_mfma_f32_16x16x32_bf16 v[24:27], v[16:19], a[64:67], 0
    ds_read_b64_tr_b16 a[24:25], v8 offset:3072
    ds_read_b64_tr_b16 a[26:27], v8 offset:3328
    v_mfma_f32_32x32x16_bf16 v[48:63], v[148:151], a[12:15], v[48:63]
    buffer_load_dwordx4 v3, s[8:11], s52 offen offset:1024 lds
    ds_read_b64_tr_b16 a[28:29], v9 offset:3072
    buffer_load_dwordx4 v4, s[8:11], s52 offen offset:2048 lds
    ds_read_b64_tr_b16 a[30:31], v9 offset:3328
    s_waitcnt lgkmcnt(10)
    v_mfma_f32_16x16x32_bf16 v[28:31], v[16:19], a[68:71], 0
    buffer_load_dwordx4 v5, s[8:11], s52 offen offset:3072 lds
    v_dot2_f32_bf16 v64, v144, v144, 0
    v_dot2_f32_bf16 v65, v145, v145, 0
    v_dot2_f32_bf16 v64, v146, v146, v64
    v_dot2_f32_bf16 v65, v147, v147, v65
    v_dot2_f32_bf16 v64, v148, v148, v64
    v_dot2_f32_bf16 v65, v149, v149, v65
    v_dot2_f32_bf16 v64, v150, v150, v64
    v_dot2_f32_bf16 v65, v151, v151, v65
    s_waitcnt lgkmcnt(9)
    v_dot2_f32_bf16 v64, v152, v152, v64
    v_dot2_f32_bf16 v65, v153, v153, v65
    v_dot2_f32_bf16 v64, v154, v154, v64
    v_dot2_f32_bf16 v65, v155, v155, v65
    s_waitcnt lgkmcnt(4)
    v_dot2_f32_bf16 v64, v156, v156, v64
    v_dot2_f32_bf16 v65, v157, v157, v65
    v_dot2_f32_bf16 v64, v158, v158, v64
    v_dot2_f32_bf16 v65, v159, v159, v65
    s_waitcnt vmcnt(6)
    s_barrier
    v_mfma_f32_16x16x32_bf16 v[20:23], v[16:19], v[148:151], v[20:23]
    ds_read_b128 v[160:163], v11 offset:4096
    ds_read_b64_tr_b16 a[32:33], v8 offset:4096
    ds_read_b64_tr_b16 a[34:35], v8 offset:4352
    v_mfma_f32_32x32x16_bf16 v[32:47], v[152:155], a[16:19], v[32:47]
    s_mul_i32 s53, s61, 172032
    s_lshl_b32 s52, s61, 7
    s_add_u32 s53, s53, s63
    s_add_u32 s52, s52, s62
    ds_read_b64_tr_b16 a[36:37], v9 offset:4096
    ds_read_b64_tr_b16 a[38:39], v9 offset:4352
    ds_read_b128 v[164:167], v12 offset:4096
    s_add_u32 m0, s65, 60544
    s_add_u32 s61, s61, 1
    buffer_load_dwordx4 v6, s[12:15], s53 offen offset:896 lds
    ds_read_b64_tr_b16 a[40:41], v8 offset:5120
    v_mfma_f32_32x32x16_bf16 v[48:63], v[152:155], a[20:23], v[48:63]
    ds_read_b64_tr_b16 a[42:43], v8 offset:5376
    s_add_u32 m0, s65, 89216
    s_cmp_eq_u32 s61, 7
    buffer_load_dwordx4 v7, s[12:15], s53 offen offset:896 lds
    s_cselect_b32 s61, 0, s61
    ds_read_b64_tr_b16 a[44:45], v9 offset:5120
    ds_read_b64_tr_b16 a[46:47], v9 offset:5376
    ds_read_b128 v[168:171], v13 offset:4096
    s_add_u32 m0, s64, 0
    s_nop 0
    buffer_load_dwordx4 v2, s[8:11], s52 offen lds
    ds_read_b64_tr_b16 a[48:49], v8 offset:6144
    v_mfma_f32_16x16x32_bf16 v[20:23], v[16:19], v[152:155], v[20:23]
    ds_read_b64_tr_b16 a[50:51], v8 offset:6400
    ds_read_b64_tr_b16 a[52:53], v9 offset:6144
    s_waitcnt lgkmcnt(15)
    v_mfma_f32_32x32x16_bf16 v[32:47], v[156:159], a[24:27], v[32:47]
    buffer_load_dwordx4 v3, s[8:11], s52 offen offset:1024 lds
    ds_read_b64_tr_b16 a[54:55], v9 offset:6400
    ds_read_b128 v[172:175], v14 offset:4096
    buffer_load_dwordx4 v4, s[8:11], s52 offen offset:2048 lds
    ds_read_b64_tr_b16 a[56:57], v8 offset:7168
    ds_read_b64_tr_b16 a[58:59], v8 offset:7424
    ds_read_b64_tr_b16 a[60:61], v9 offset:7168
    s_waitcnt lgkmcnt(15)
    v_mfma_f32_32x32x16_bf16 v[48:63], v[156:159], a[28:31], v[48:63]
    buffer_load_dwordx4 v5, s[8:11], s52 offen offset:3072 lds
    ds_read_b64_tr_b16 a[62:63], v9 offset:7424
    ds_read_b64_tr_b16 a[72:73], v125 offset:4096
    ds_read_b64_tr_b16 a[74:75], v125 offset:4352
    s_mov_b64 exec, 1
    buffer_store_dword v118, off, s[32:35], s55 sc1
    s_mov_b64 exec, -1
    ds_read_b64_tr_b16 a[76:77], v126 offset:4096
    v_mfma_f32_16x16x32_bf16 v[20:23], v[16:19], v[156:159], v[20:23]
    ds_read_b64_tr_b16 a[78:79], v126 offset:4352
    buffer_store_dwordx4 v[120:123], v119, s[32:35], 0 offen sc1
    v_mfma_f32_32x32x16_bf16 v[32:47], v[160:163], a[32:35], v[32:47]
    s_waitcnt lgkmcnt(15)
    v_mfma_f32_32x32x16_bf16 v[48:63], v[160:163], a[36:39], v[48:63]
    v_dot2_f32_bf16 v64, v160, v160, v64
    v_dot2_f32_bf16 v65, v161, v161, v65
    v_dot2_f32_bf16 v64, v162, v162, v64
    v_dot2_f32_bf16 v65, v163, v163, v65
    v_dot2_f32_bf16 v64, v164, v164, v64
    v_dot2_f32_bf16 v65, v165, v165, v65
    v_dot2_f32_bf16 v64, v166, v166, v64
    v_dot2_f32_bf16 v65, v167, v167, v65
    s_waitcnt lgkmcnt(13)
    v_dot2_f32_bf16 v64, v168, v168, v64
    v_dot2_f32_bf16 v65, v169, v169, v65
    v_dot2_f32_bf16 v64, v170, v170, v64
    v_dot2_f32_bf16 v65, v171, v171, v65
    s_waitcnt lgkmcnt(8)
    v_dot2_f32_bf16 v64, v172, v172, v64
    v_dot2_f32_bf16 v65, v173, v173, v65
    v_dot2_f32_bf16 v64, v174, v174, v64
    v_dot2_f32_bf16 v65, v175, v175, v65
    s_waitcnt vmcnt(8)
    s_barrier
    v_mfma_f32_16x16x32_bf16 v[20:23], v[16:19], v[160:163], v[20:23]
    ds_read_b128 v[176:179], v11 offset:8192
    ds_read_b64_tr_b16 a[0:1], v8 offset:8192
    v_mfma_f32_32x32x16_bf16 v[32:47], v[168:171], a[48:51], v[32:47]
    ds_read_b64_tr_b16 a[2:3], v8 offset:8448
    ds_read_b64_tr_b16 a[4:5], v9 offset:8192
    s_mul_i32 s53, s61, 172032
    s_lshl_b32 s52, s61, 7
    s_add_u32 s53, s53, s63
    s_add_u32 s52, s52, s62
    ds_read_b64_tr_b16 a[6:7], v9 offset:8448
    v_mfma_f32_32x32x16_bf16 v[48:63], v[168:171], a[52:55], v[48:63]
    ds_read_b128 v[180:183], v12 offset:8192
    ds_read_b64_tr_b16 a[8:9], v8 offset:9216
    s_add_u32 m0, s65, 64640
    s_add_u32 s61, s61, 1
    buffer_load_dwordx4 v6, s[12:15], s53 offen offset:896 lds
    ds_read_b64_tr_b16 a[10:11], v8 offset:9472
    v_mfma_f32_16x16x32_bf16 v[20:23], v[16:19], v[168:171], v[20:23]
    ds_read_b64_tr_b16 a[12:13], v9 offset:9216
    s_waitcnt lgkmcnt(15)
    v_mfma_f32_32x32x16_bf16 v[32:47], v[172:175], a[56:59], v[32:47]
    ds_read_b64_tr_b16 a[14:15], v9 offset:9472
    ds_read_b128 v[184:187], v13 offset:8192
    s_add_u32 m0, s65, 93312
    s_cmp_eq_u32 s61, 7
    buffer_load_dwordx4 v7, s[12:15], s53 offen offset:896 lds
    s_cselect_b32 s61, 0, s61
    ds_read_b64_tr_b16 a[16:17], v8 offset:10240
    s_waitcnt lgkmcnt(15)
    v_mfma_f32_32x32x16_bf16 v[48:63], v[172:175], a[60:63], v[48:63]
    ds_read_b64_tr_b16 a[18:19], v8 offset:10496
    ds_read_b64_tr_b16 a[20:21], v9 offset:10240
    s_add_u32 m0, s64, 4096
    s_nop 0
    buffer_load_dwordx4 v2, s[8:11], s52 offen lds
    ds_read_b64_tr_b16 a[22:23], v9 offset:10496
    v_mfma_f32_16x16x32_bf16 v[20:23], v[16:19], v[172:175], v[20:23]
    ds_read_b128 v[188:191], v14 offset:8192
    v_mfma_f32_32x32x16_bf16 v[32:47], v[164:167], a[40:43], v[32:47]
    ds_read_b64_tr_b16 a[24:25], v8 offset:11264
    ds_read_b64_tr_b16 a[26:27], v8 offset:11520
    buffer_load_dwordx4 v3, s[8:11], s52 offen offset:1024 lds
    ds_read_b64_tr_b16 a[28:29], v9 offset:11264
    s_waitcnt lgkmcnt(15)
    v_mfma_f32_16x16x32_bf16 v[24:27], v[16:19], a[72:75], v[24:27]
    ds_read_b64_tr_b16 a[30:31], v9 offset:11520
    v_mfma_f32_32x32x16_bf16 v[48:63], v[164:167], a[44:47], v[48:63]
    ds_read_b64_tr_b16 a[64:65], v125 offset:8192
    buffer_load_dwordx4 v4, s[8:11], s52 offen offset:2048 lds
    ds_read_b64_tr_b16 a[66:67], v125 offset:8448
    ds_read_b64_tr_b16 a[68:69], v126 offset:8192
    v_mfma_f32_16x16x32_bf16 v[28:31], v[16:19], a[76:79], v[28:31]
    ds_read_b64_tr_b16 a[70:71], v126 offset:8448
    v_mfma_f32_16x16x32_bf16 v[20:23], v[16:19], v[164:167], v[20:23]
    buffer_load_dwordx4 v5, s[8:11], s52 offen offset:3072 lds
    v_mfma_f32_32x32x16_bf16 v[32:47], v[176:179], a[0:3], v[32:47]
    s_waitcnt lgkmcnt(15)
    v_mfma_f32_32x32x16_bf16 v[48:63], v[176:179], a[4:7], v[48:63]
    v_dot2_f32_bf16 v64, v176, v176, v64
    v_dot2_f32_bf16 v65, v177, v177, v65
    v_dot2_f32_bf16 v64, v178, v178, v64
    v_dot2_f32_bf16 v65, v179, v179, v65
    v_dot2_f32_bf16 v64, v180, v180, v64
    v_dot2_f32_bf16 v65, v181, v181, v65
    v_dot2_f32_bf16 v64, v182, v182, v64
    v_dot2_f32_bf16 v65, v183, v183, v65
    s_waitcnt lgkmcnt(13)
    v_dot2_f32_bf16 v64, v184, v184, v64
    v_dot2_f32_bf16 v65, v185, v185, v65
    v_dot2_f32_bf16 v64, v186, v186, v64
    v_dot2_f32_bf16 v65, v187, v187, v65
    s_waitcnt lgkmcnt(8)
    v_dot2_f32_bf16 v64, v188, v188, v64
    v_dot2_f32_bf16 v65, v189, v189, v65
    v_dot2_f32_bf16 v64, v190, v190, v64
    v_dot2_f32_bf16 v65, v191, v191, v65
    s_waitcnt vmcnt(8)
    s_barrier
    v_mfma_f32_16x16x32_bf16 v[20:23], v[16:19], v[176:179], v[20:23]
    ds_read_b128 v[192:195], v11 offset:0
    ds_read_b64_tr_b16 a[32:33], v8 offset:12288
    v_mfma_f32_32x32x16_bf16 v[32:47], v[184:187], a[16:19], v[32:47]
    ds_read_b64_tr_b16 a[34:35], v8 offset:12544
    s_mul_i32 s53, s61, 172032
    s_lshl_b32 s52, s61, 7
    s_add_u32 s53, s53, s63
    s_add_u32 s52, s52, s62
    ds_read_b64_tr_b16 a[36:37], v9 offset:12288
    ds_read_b64_tr_b16 a[38:39], v9 offset:12544
    v_mfma_f32_32x32x16_bf16 v[48:63], v[184:187], a[20:23], v[48:63]
    ds_read_b128 v[196:199], v12 offset:0
    s_add_u32 m0, s65, 68736
    s_add_u32 s61, s61, 1
    buffer_load_dwordx4 v6, s[12:15], s53 offen offset:896 lds
    ds_read_b64_tr_b16 a[40:41], v8 offset:13312
    ds_read_b64_tr_b16 a[42:43], v8 offset:13568
    v_mfma_f32_16x16x32_bf16 v[20:23], v[16:19], v[184:187], v[20:23]
    s_add_u32 m0, s65, 97408
    s_cmp_eq_u32 s61, 7
    buffer_load_dwordx4 v7, s[12:15], s53 offen offset:896 lds
    s_cselect_b32 s61, 0, s61
    s_waitcnt lgkmcnt(14)
    v_mfma_f32_32x32x16_bf16 v[32:47], v[188:191], a[24:27], v[32:47]
    ds_read_b64_tr_b16 a[44:45], v9 offset:13312
    ds_read_b64_tr_b16 a[46:47], v9 offset:13568
    ds_read_b128 v[200:203], v13 offset:0
    s_add_u32 m0, s64, 8192
    s_nop 0
    buffer_load_dwordx4 v2, s[8:11], s52 offen lds
    ds_read_b64_tr_b16 a[48:49], v8 offset:14336
    s_waitcnt lgkmcnt(15)
    v_mfma_f32_32x32x16_bf16 v[48:63], v[188:191], a[28:31], v[48:63]
    ds_read_b64_tr_b16 a[50:51], v8 offset:14592
    ds_read_b64_tr_b16 a[52:53], v9 offset:14336
    buffer_load_dwordx4 v3, s[8:11], s52 offen offset:1024 lds
    ds_read_b64_tr_b16 a[54:55], v9 offset:14592
    v_mfma_f32_16x16x32_bf16 v[20:23], v[16:19], v[188:191], v[20:23]
    ds_read_b128 v[204:207], v14 offset:0
    v_mfma_f32_32x32x16_bf16 v[32:47], v[180:183], a[8:11], v[32:47]
    buffer_load_dwordx4 v4, s[8:11], s52 offen offset:2048 lds
    ds_read_b64_tr_b16 a[56:57], v8 offset:15360
    ds_read_b64_tr_b16 a[58:59], v8 offset:15616
    ds_read_b64_tr_b16 a[60:61], v9 offset:15360
    s_waitcnt lgkmcnt(15)
    v_mfma_f32_16x16x32_bf16 v[24:27], v[16:19], a[64:67], v[24:27]
    buffer_load_dwordx4 v5, s[8:11], s52 offen offset:3072 lds
    ds_read_b64_tr_b16 a[62:63], v9 offset:15616
    v_mfma_f32_32x32x16_bf16 v[48:63], v[180:183], a[12:15], v[48:63]
    ds_read_b64_tr_b16 a[72:73], v125 offset:12288
    ds_read_b64_tr_b16 a[74:75], v125 offset:12544
    v_lshrrev_b32 v80, 2, v1
    v_mul_u32_u24 v80, 896, v80
    v_and_b32 v81, 3, v1
    v_lshl_add_u32 v80, v81, 4, v80
    s_lshl_b32 s46, s6, 11
    s_add_u32 m0, s46, 106496
    s_add_u32 s47, s78, 13312
    buffer_load_dwordx4 v80, s[8:11], s78 offen lds
    ds_read_b64_tr_b16 a[76:77], v126 offset:12288
    v_mfma_f32_16x16x32_bf16 v[28:31], v[16:19], a[68:71], v[28:31]
    ds_read_b64_tr_b16 a[78:79], v126 offset:12544
    v_mfma_f32_16x16x32_bf16 v[20:23], v[16:19], v[180:183], v[20:23]
    buffer_load_dwordx4 v80, s[8:11], s47 offen offset:1024 lds
    v_and_b32 v80, 31, v1
    v_lshrrev_b32 v81, 5, v1
    v_lshl_add_u32 v80, v80, 3, v81
    s_add_u32 s46, s46, 106496
    v_lshl_add_u32 v81, v80, 3, s46
    v_mfma_f32_32x32x16_bf16 v[32:47], v[192:195], a[32:35], v[32:47]
    s_waitcnt lgkmcnt(15)
    v_mfma_f32_32x32x16_bf16 v[48:63], v[192:195], a[36:39], v[48:63]
    v_dot2_f32_bf16 v64, v192, v192, v64
    v_dot2_f32_bf16 v65, v193, v193, v65
    v_dot2_f32_bf16 v64, v194, v194, v64
    v_dot2_f32_bf16 v65, v195, v195, v65
    v_dot2_f32_bf16 v64, v196, v196, v64
    v_dot2_f32_bf16 v65, v197, v197, v65
    v_dot2_f32_bf16 v64, v198, v198, v64
    v_dot2_f32_bf16 v65, v199, v199, v65
    s_waitcnt lgkmcnt(13)
    v_dot2_f32_bf16 v64, v200, v200, v64
    v_dot2_f32_bf16 v65, v201, v201, v65
    v_dot2_f32_bf16 v64, v202, v202, v64
    v_dot2_f32_bf16 v65, v203, v203, v65
    s_waitcnt lgkmcnt(8)
    v_dot2_f32_bf16 v64, v204, v204, v64
    v_dot2_f32_bf16 v65, v205, v205, v65
    v_dot2_f32_bf16 v64, v206, v206, v64
    v_dot2_f32_bf16 v65, v207, v207, v65
    s_waitcnt vmcnt(8)
    s_barrier
    v_mfma_f32_16x16x32_bf16 v[20:23], v[16:19], v[192:195], v[20:23]
    ds_read_b128 v[208:211], v11 offset:4096
    ds_read_b64_tr_b16 a[0:1], v8 offset:16384
    v_mfma_f32_32x32x16_bf16 v[32:47], v[200:203], a[48:51], v[32:47]
    ds_read_b64_tr_b16 a[2:3], v8 offset:16640
    ds_read_b64_tr_b16 a[4:5], v9 offset:16384
    s_mul_i32 s53, s61, 172032
    s_lshl_b32 s52, s61, 7
    s_add_u32 s53, s53, s63
    s_add_u32 s52, s52, s62
    ds_read_b64_tr_b16 a[6:7], v9 offset:16640
    v_mfma_f32_32x32x16_bf16 v[48:63], v[200:203], a[52:55], v[48:63]
    ds_read_b128 v[212:215], v12 offset:4096
    ds_read_b64_tr_b16 a[8:9], v8 offset:17408
    s_add_u32 m0, s65, 72832
    s_add_u32 s61, s61, 1
    buffer_load_dwordx4 v6, s[12:15], s53 offen offset:896 lds
    ds_read_b64_tr_b16 a[10:11], v8 offset:17664
    v_mfma_f32_16x16x32_bf16 v[20:23], v[16:19], v[200:203], v[20:23]
    ds_read_b64_tr_b16 a[12:13], v9 offset:17408
    s_waitcnt lgkmcnt(15)
    v_mfma_f32_32x32x16_bf16 v[32:47], v[204:207], a[56:59], v[32:47]
    ds_read_b64_tr_b16 a[14:15], v9 offset:17664
    ds_read_b128 v[216:219], v13 offset:4096
    s_add_u32 m0, s65, 101504
    s_cmp_eq_u32 s61, 7
    buffer_load_dwordx4 v7, s[12:15], s53 offen offset:896 lds
    s_cselect_b32 s61, 0, s61
    ds_read_b64_tr_b16 a[16:17], v8 offset:18432
    s_waitcnt lgkmcnt(15)
    v_mfma_f32_32x32x16_bf16 v[48:63], v[204:207], a[60:63], v[48:63]
    ds_read_b64_tr_b16 a[18:19], v8 offset:18688
    ds_read_b64_tr_b16 a[20:21], v9 offset:18432
    s_add_u32 m0, s64, 0
    s_nop 0
    buffer_load_dwordx4 v2, s[8:11], s52 offen lds
    ds_read_b64_tr_b16 a[22:23], v9 offset:18688
    v_mfma_f32_16x16x32_bf16 v[20:23], v[16:19], v[204:207], v[20:23]
    ds_read_b128 v[220:223], v14 offset:4096
    v_mfma_f32_32x32x16_bf16 v[32:47], v[196:199], a[40:43], v[32:47]
    ds_read_b64_tr_b16 a[24:25], v8 offset:19456
    ds_read_b64_tr_b16 a[26:27], v8 offset:19712
    buffer_load_dwordx4 v3, s[8:11], s52 offen offset:1024 lds
    ds_read_b64_tr_b16 a[28:29], v9 offset:19456
    s_waitcnt lgkmcnt(15)
    v_mfma_f32_16x16x32_bf16 v[24:27], v[16:19], a[72:75], v[24:27]
    ds_read_b64_tr_b16 a[30:31], v9 offset:19712
    v_mfma_f32_32x32x16_bf16 v[48:63], v[196:199], a[44:47], v[48:63]
    ds_read_b64_tr_b16 a[64:65], v125 offset:16384
    buffer_load_dwordx4 v4, s[8:11], s52 offen offset:2048 lds
    ds_read_b64_tr_b16 a[66:67], v125 offset:16640
    ds_read_b64_tr_b16 a[68:69], v126 offset:16384
    v_mfma_f32_16x16x32_bf16 v[28:31], v[16:19], a[76:79], v[28:31]
    ds_read_b64_tr_b16 a[70:71], v126 offset:16640
    v_mfma_f32_16x16x32_bf16 v[20:23], v[16:19], v[196:199], v[20:23]
    buffer_load_dwordx4 v5, s[8:11], s52 offen offset:3072 lds
    v_mfma_f32_32x32x16_bf16 v[32:47], v[208:211], a[0:3], v[32:47]
    s_waitcnt lgkmcnt(15)
    v_mfma_f32_32x32x16_bf16 v[48:63], v[208:211], a[4:7], v[48:63]
    v_dot2_f32_bf16 v64, v208, v208, v64
    v_dot2_f32_bf16 v65, v209, v209, v65
    v_dot2_f32_bf16 v64, v210, v210, v64
    v_dot2_f32_bf16 v65, v211, v211, v65
    v_dot2_f32_bf16 v64, v212, v212, v64
    v_dot2_f32_bf16 v65, v213, v213, v65
    v_dot2_f32_bf16 v64, v214, v214, v64
    v_dot2_f32_bf16 v65, v215, v215, v65
    s_waitcnt lgkmcnt(13)
    v_dot2_f32_bf16 v64, v216, v216, v64
    v_dot2_f32_bf16 v65, v217, v217, v65
    v_dot2_f32_bf16 v64, v218, v218, v64
    v_dot2_f32_bf16 v65, v219, v219, v65
    s_waitcnt lgkmcnt(8)
    v_dot2_f32_bf16 v64, v220, v220, v64
    v_dot2_f32_bf16 v65, v221, v221, v65
    v_dot2_f32_bf16 v64, v222, v222, v64
    v_dot2_f32_bf16 v65, v223, v223, v65
    s_waitcnt vmcnt(8)
    s_barrier
    v_mfma_f32_16x16x32_bf16 v[20:23], v[16:19], v[208:211], v[20:23]
    ds_read_b128 v[224:227], v11 offset:8192
    ds_read_b64_tr_b16 a[32:33], v8 offset:20480
    v_mfma_f32_32x32x16_bf16 v[32:47], v[216:219], a[16:19], v[32:47]
    ds_read_b64_tr_b16 a[34:35], v8 offset:20736
    ds_read_b64_tr_b16 a[36:37], v9 offset:20480
    ds_read_b64_tr_b16 a[38:39], v9 offset:20736
    v_mfma_f32_32x32x16_bf16 v[48:63], v[216:219], a[20:23], v[48:63]
    ds_read_b128 v[228:231], v12 offset:8192
    ds_read_b64_tr_b16 a[40:41], v8 offset:21504
    ds_read_b64_tr_b16 a[42:43], v8 offset:21760
    v_mfma_f32_16x16x32_bf16 v[20:23], v[16:19], v[216:219], v[20:23]
    s_mov_b64 exec, 1
    buffer_store_dword v100, off, s[32:35], s66 sc1
    s_mov_b64 exec, -1
    s_waitcnt lgkmcnt(14)
    v_mfma_f32_32x32x16_bf16 v[32:47], v[220:223], a[24:27], v[32:47]
    ds_read_b64_tr_b16 a[44:45], v9 offset:21504
    ds_read_b64_tr_b16 a[46:47], v9 offset:21760
    ds_read_b128 v[232:235], v13 offset:8192
    ds_read_b64_tr_b16 a[48:49], v8 offset:22528
    s_waitcnt lgkmcnt(15)
    v_mfma_f32_32x32x16_bf16 v[48:63], v[220:223], a[28:31], v[48:63]
    ds_read_b64_tr_b16 a[50:51], v8 offset:22784
    ds_read_b64_tr_b16 a[52:53], v9 offset:22528
    ds_read_b64_tr_b16 a[54:55], v9 offset:22784
    v_mfma_f32_16x16x32_bf16 v[20:23], v[16:19], v[220:223], v[20:23]
    ds_read_b128 v[236:239], v14 offset:8192
    v_mfma_f32_32x32x16_bf16 v[32:47], v[212:215], a[8:11], v[32:47]
    s_mul_i32 s53, s61, 172032
    s_add_u32 m0, s65, 114688
    s_add_u32 s53, s53, s63
    buffer_load_dwordx4 v6, s[12:15], s53 offen lds
    s_add_u32 s61, s61, 1
    s_cmp_eq_u32 s61, 7
    s_cselect_b32 s61, 0, s61
    ds_read_b64_tr_b16 a[56:57], v8 offset:23552
    ds_read_b64_tr_b16 a[58:59], v8 offset:23808
    ds_read_b64_tr_b16 a[60:61], v9 offset:23552
    s_waitcnt lgkmcnt(15)
    v_mfma_f32_16x16x32_bf16 v[24:27], v[16:19], a[64:67], v[24:27]
    ds_read_b64_tr_b16 a[62:63], v9 offset:23808
    v_mfma_f32_32x32x16_bf16 v[48:63], v[212:215], a[12:15], v[48:63]
    ds_read_b64_tr_b16 a[72:73], v125 offset:20480
    ds_read_b64_tr_b16 a[74:75], v125 offset:20736
    ds_read_b64_tr_b16 a[76:77], v126 offset:20480
    v_mfma_f32_16x16x32_bf16 v[28:31], v[16:19], a[68:71], v[28:31]
    ds_read_b64_tr_b16 a[78:79], v126 offset:20736
    v_mfma_f32_16x16x32_bf16 v[20:23], v[16:19], v[212:215], v[20:23]
    s_mul_i32 s53, s61, 172032
    s_add_u32 m0, s65, 118784
    s_add_u32 s53, s53, s63
    buffer_load_dwordx4 v6, s[12:15], s53 offen lds
    s_add_u32 s61, s61, 1
    s_cmp_eq_u32 s61, 7
    s_cselect_b32 s61, 0, s61
    v_mfma_f32_32x32x16_bf16 v[32:47], v[224:227], a[32:35], v[32:47]
    s_waitcnt vmcnt(9)
    ds_read_b64 a[216:217], v81 offset:0
    ds_read_b64 a[218:219], v81 offset:16
    s_waitcnt lgkmcnt(15)
    v_mfma_f32_32x32x16_bf16 v[48:63], v[224:227], a[36:39], v[48:63]
    ds_read_b64 a[220:221], v81 offset:32
    ds_read_b64 a[222:223], v81 offset:48
    v_dot2_f32_bf16 v64, v224, v224, v64
    v_dot2_f32_bf16 v65, v225, v225, v65
    v_dot2_f32_bf16 v64, v226, v226, v64
    v_dot2_f32_bf16 v65, v227, v227, v65
    v_dot2_f32_bf16 v64, v228, v228, v64
    v_dot2_f32_bf16 v65, v229, v229, v65
    v_dot2_f32_bf16 v64, v230, v230, v64
    v_dot2_f32_bf16 v65, v231, v231, v65
    v_dot2_f32_bf16 v64, v232, v232, v64
    v_dot2_f32_bf16 v65, v233, v233, v65
    v_dot2_f32_bf16 v64, v234, v234, v64
    v_dot2_f32_bf16 v65, v235, v235, v65
    s_waitcnt lgkmcnt(12)
    v_dot2_f32_bf16 v64, v236, v236, v64
    v_dot2_f32_bf16 v65, v237, v237, v65
    v_dot2_f32_bf16 v64, v238, v238, v64
    v_dot2_f32_bf16 v65, v239, v239, v65
    s_waitcnt vmcnt(3)
    s_barrier
    v_mfma_f32_16x16x32_bf16 v[20:23], v[16:19], v[224:227], v[20:23]
    ds_read_b128 v[240:243], v11 offset:0
    ds_read_b128 v[244:247], v12 offset:0
    v_mfma_f32_32x32x16_bf16 v[32:47], v[232:235], a[48:51], v[32:47]
    ds_read_b128 v[248:251], v13 offset:0
    ds_read_b128 v[252:255], v14 offset:0
    ds_read_b64_tr_b16 a[64:65], v125 offset:24576
    v_mfma_f32_32x32x16_bf16 v[48:63], v[232:235], a[52:55], v[48:63]
    s_mul_i32 s53, s61, 172032
    s_add_u32 m0, s65, 122880
    s_add_u32 s53, s53, s63
    buffer_load_dwordx4 v6, s[12:15], s53 offen lds
    s_add_u32 s61, s61, 1
    s_cmp_eq_u32 s61, 7
    s_cselect_b32 s61, 0, s61
    ds_read_b64_tr_b16 a[66:67], v125 offset:24832
    ds_read_b64_tr_b16 a[68:69], v126 offset:24576
    ds_read_b64_tr_b16 a[70:71], v126 offset:24832
    v_mfma_f32_16x16x32_bf16 v[20:23], v[16:19], v[232:235], v[20:23]
    ds_read_b64_tr_b16 a[0:1], v8 offset:24576
    s_waitcnt lgkmcnt(15)
    v_mfma_f32_32x32x16_bf16 v[32:47], v[236:239], a[56:59], v[32:47]
    ds_read_b64_tr_b16 a[2:3], v8 offset:24832
    s_mul_i32 s53, s61, 172032
    s_add_u32 m0, s65, 126976
    s_add_u32 s53, s53, s63
    buffer_load_dwordx4 v6, s[12:15], s53 offen lds
    s_add_u32 s61, s61, 1
    s_cmp_eq_u32 s61, 7
    s_cselect_b32 s61, 0, s61
    ds_read_b64_tr_b16 a[4:5], v9 offset:24576
    ds_read_b64_tr_b16 a[6:7], v9 offset:24832
    v_mfma_f32_32x32x16_bf16 v[48:63], v[236:239], a[60:63], v[48:63]
    ds_read_b64_tr_b16 a[8:9], v8 offset:25600
    ds_read_b64_tr_b16 a[10:11], v8 offset:25856
    ds_read_b64_tr_b16 a[12:13], v9 offset:25600
    v_mfma_f32_16x16x32_bf16 v[20:23], v[16:19], v[236:239], v[20:23]
    s_mul_i32 s53, s61, 172032
    s_add_u32 m0, s65, 131072
    s_add_u32 s53, s53, s63
    buffer_load_dwordx4 v6, s[12:15], s53 offen lds
    s_add_u32 s61, s61, 1
    s_cmp_eq_u32 s61, 7
    s_cselect_b32 s61, 0, s61
    ds_read_b64_tr_b16 a[14:15], v9 offset:25856
    v_mfma_f32_32x32x16_bf16 v[32:47], v[228:231], a[40:43], v[32:47]
    ds_read_b64_tr_b16 a[16:17], v8 offset:26624
    ds_read_b64_tr_b16 a[18:19], v8 offset:26880
    ds_read_b64_tr_b16 a[20:21], v9 offset:26624
    v_mfma_f32_16x16x32_bf16 v[24:27], v[16:19], a[72:75], v[24:27]
    ds_read_b64_tr_b16 a[22:23], v9 offset:26880
    v_mfma_f32_32x32x16_bf16 v[48:63], v[228:231], a[44:47], v[48:63]
    s_mul_i32 s53, s61, 172032
    s_add_u32 m0, s65, 135168
    s_add_u32 s53, s53, s63
    buffer_load_dwordx4 v6, s[12:15], s53 offen lds
    s_add_u32 s61, s61, 1
    s_cmp_eq_u32 s61, 7
    s_cselect_b32 s61, 0, s61
    ds_read_b64_tr_b16 a[24:25], v8 offset:27648
    ds_read_b64_tr_b16 a[26:27], v8 offset:27904
    ds_read_b64_tr_b16 a[28:29], v9 offset:27648
    s_waitcnt lgkmcnt(15)
    v_mfma_f32_16x16x32_bf16 v[28:31], v[16:19], a[76:79], v[28:31]
    ds_read_b64_tr_b16 a[30:31], v9 offset:27904
    v_mfma_f32_16x16x32_bf16 v[20:23], v[16:19], v[228:231], v[20:23]
    buffer_load_dword v102, v101, s[32:35], 0 offen sc1
    v_mfma_f32_16x16x32_bf16 v[20:23], v[16:19], v[240:243], v[20:23]
    v_mfma_f32_16x16x32_bf16 v[20:23], v[16:19], v[244:247], v[20:23]
    v_mfma_f32_16x16x32_bf16 v[20:23], v[16:19], v[248:251], v[20:23]
    v_mfma_f32_16x16x32_bf16 v[20:23], v[16:19], v[252:255], v[20:23]
    v_dot2_f32_bf16 v64, v240, v240, v64
    v_dot2_f32_bf16 v65, v241, v241, v65
    v_dot2_f32_bf16 v64, v242, v242, v64
    v_dot2_f32_bf16 v65, v243, v243, v65
    v_dot2_f32_bf16 v64, v244, v244, v64
    v_dot2_f32_bf16 v65, v245, v245, v65
    v_dot2_f32_bf16 v64, v246, v246, v64
    v_dot2_f32_bf16 v65, v247, v247, v65
    v_dot2_f32_bf16 v64, v248, v248, v64
    v_dot2_f32_bf16 v65, v249, v249, v65
    v_dot2_f32_bf16 v64, v250, v250, v64
    v_dot2_f32_bf16 v65, v251, v251, v65
    v_dot2_f32_bf16 v64, v252, v252, v64
    v_dot2_f32_bf16 v65, v253, v253, v65
    v_dot2_f32_bf16 v64, v254, v254, v64
    v_dot2_f32_bf16 v65, v255, v255, v65
    s_nop 2
    v_add_f32 v104, v64, v65
    v_mov_b32 v105, v104
    s_nop 1
    v_permlane32_swap_b32 v104, v105
    v_add_f32 v104, v104, v105
    v_lshrrev_b32 v3, 5, v1
    v_mul_u32_u24 v3, 384, v3
    v_lshl_add_u32 v3, v1, 2, v3
    v_add_u32 v3, 160768, v3
    v_mfma_f32_16x16x32_bf16 v[24:27], v[16:19], a[64:67], v[24:27]
    v_mfma_f32_16x16x32_bf16 v[28:31], v[16:19], a[68:71], v[28:31]
    s_waitcnt lgkmcnt(14)
    v_mfma_f32_32x32x16_bf16 v[32:47], v[240:243], a[0:3], v[32:47]
    v_mul_f32 v106, 0x3b124925, v20
    v_mul_f32 v80, 0x3b124925, v104
    v_fma_f32 v80, -v106, v106, v80
    v_max_f32 v80, 0, v80
    v_cvt_pk_bf16_f32 v80, v80, v80
    v_and_b32 v80, 0xffff0000, v80
    s_mul_i32 s53, s61, 172032
    s_add_u32 m0, s65, 139264
    s_add_u32 s53, s53, s63
    buffer_load_dwordx4 v6, s[12:15], s53 offen lds
    s_waitcnt lgkmcnt(12)
    v_mfma_f32_32x32x16_bf16 v[48:63], v[240:243], a[4:7], v[48:63]
    v_add_f32 v80, 0x3727c5ac, v80
    v_cvt_pk_bf16_f32 v80, v80, v80
    v_and_b32 v80, 0xffff0000, v80
    v_sqrt_f32 v80, v80
    s_nop 0
    v_cvt_pk_bf16_f32 v80, v80, v80
    v_and_b32 v107, 0xffff0000, v80
    buffer_load_dword v110, v15, s[32:35], 0 offen sc1
    s_waitcnt lgkmcnt(10)
    v_mfma_f32_32x32x16_bf16 v[32:47], v[244:247], a[8:11], v[32:47]
    v_cvt_pk_bf16_f32 v82, v24, v24
    v_and_b32 v82, 0xffff0000, v82
    v_sub_f32 v92, v24, v82
    v_cvt_pk_bf16_f32 v92, v82, v92
    v_cvt_pk_bf16_f32 v83, v28, v28
    s_waitcnt lgkmcnt(8)
    v_mfma_f32_32x32x16_bf16 v[48:63], v[244:247], a[12:15], v[48:63]
    v_and_b32 v83, 0xffff0000, v83
    v_sub_f32 v96, v28, v83
    v_cvt_pk_bf16_f32 v96, v83, v96
    ds_write_b32 v84, v92 offset:1024
    ds_write_b32 v84, v96 offset:2048
    s_waitcnt lgkmcnt(8)
    v_mfma_f32_32x32x16_bf16 v[32:47], v[248:251], a[16:19], v[32:47]
    v_rcp_f32 v109, v107
    v_cvt_pk_bf16_f32 v80, -v106, -v106
    v_mul_f32 v108, 0x3fb8aa3b, v109
    v_mov_b32 v88, v80
    v_mov_b32 v89, v80
    v_cndmask_b32_e64 v81, v108, v109, s[48:49]
    ds_write_b32 v84, v81
    ds_read_b128 v[112:115], v85 offset:128
    s_waitcnt lgkmcnt(8)
    v_mfma_f32_32x32x16_bf16 v[48:63], v[248:251], a[20:23], v[48:63]
    ds_read_b128 v[116:119], v85 offset:160
    ds_read_b128 v[120:123], v85 offset:192
    ds_read_b128 v[124:127], v85 offset:224
    ds_read_b128 v[64:67], v85 offset:0
    ds_read_b128 v[68:71], v85 offset:32
    ds_read_b128 v[72:75], v85 offset:64
    ds_read_b128 v[76:79], v85 offset:96
    s_waitcnt lgkmcnt(9)
    s_barrier
    ds_read2st64_b32 v[96:97], v3 offset0:4 offset1:5
    ds_read2st64_b32 v[92:93], v3 offset0:0 offset1:1
    v_mfma_f32_32x32x16_bf16 v[32:47], v[252:255], a[24:27], v[32:47]
    s_lshl_b32 s3, s2, 2
    s_add_u32 s3, s3, s6
    s_mul_i32 s55, s3, 1664
    v_min_u32 v82, 12, v1
    v_lshlrev_b32 v82, 7, v82
    s_lshl_b32 s3, s3, 9
    v_and_b32 v83, 0x180, v82
    buffer_load_dword v110, v83, s[16:19], s3 offen
    buffer_load_dword v110, v82, s[20:23], s55 offen
    buffer_load_dword v110, v82, s[24:27], s55 offen
    v_mfma_f32_32x32x16_bf16 v[48:63], v[252:255], a[28:31], v[48:63]
    v_lshlrev_b32 v82, 5, v1
    buffer_load_dword v110, v82, s[32:35], s69 offen sc1
    s_waitcnt lgkmcnt(1)
    v_mfma_f32_32x32x16_bf16 v[48:63], v[88:91], v[96:99], v[48:63]
    s_waitcnt lgkmcnt(0)
    v_mfma_f32_32x32x16_bf16 v[32:47], v[88:91], v[92:95], v[32:47]
    v_accvgpr_read_b32 v7, a195
    s_nop 8
    v_pk_mul_f32 v[48:49], v[48:49], v[64:65]
    v_pk_mul_f32 v[50:51], v[50:51], v[66:67]
    v_pk_mul_f32 v[52:53], v[52:53], v[68:69]
    v_pk_mul_f32 v[54:55], v[54:55], v[70:71]
    v_pk_mul_f32 v[56:57], v[56:57], v[72:73]
    buffer_load_dwordx2 a[208:209], v128, s[40:43], 0 offen offset:0
    v_pk_mul_f32 v[58:59], v[58:59], v[74:75]
    v_pk_mul_f32 v[60:61], v[60:61], v[76:77]
    v_pk_mul_f32 v[62:63], v[62:63], v[78:79]
    s_mov_b64 exec, s[50:51]
    v_cvt_pk_bf16_f32 v136, v48, v49
    v_cvt_pk_bf16_f32 v137, v50, v51
    v_cvt_pk_bf16_f32 v138, v52, v53
    v_cvt_pk_bf16_f32 v139, v54, v55
    v_cvt_pk_bf16_f32 v140, v56, v57
    v_cvt_pk_bf16_f32 v141, v58, v59
    v_cvt_pk_bf16_f32 v142, v60, v61
    v_cvt_pk_bf16_f32 v143, v62, v63
    s_mov_b64 exec, -1
    buffer_load_dwordx2 a[210:211], v128, s[40:43], 0 offen offset:16
    v_pk_mul_f32 v[32:33], v[32:33], v[112:113]
    v_pk_mul_f32 v[34:35], v[34:35], v[114:115]
    v_pk_mul_f32 v[36:37], v[36:37], v[116:117]
    v_pk_mul_f32 v[38:39], v[38:39], v[118:119]
    v_pk_mul_f32 v[40:41], v[40:41], v[120:121]
    buffer_load_dwordx2 a[212:213], v128, s[40:43], 0 offen offset:32
    v_pk_mul_f32 v[42:43], v[42:43], v[122:123]
    v_pk_mul_f32 v[44:45], v[44:45], v[124:125]
    v_pk_mul_f32 v[46:47], v[46:47], v[126:127]
    v_exp_f32_e64 v112, v32 clamp
    buffer_load_dwordx2 a[214:215], v128, s[40:43], 0 offen offset:48
    v_max_f32 v32, 0x35c1a2a0, v32
    v_exp_f32_e64 v113, v33 clamp
    v_max_f32 v33, 0x35c1a2a0, v33
    s_add_u32 m0, s72, 0
    s_add_u32 s52, s71, 0
    buffer_load_dwordx4 v7, s[16:19], s52 offen lds
    v_exp_f32_e64 v114, v34 clamp
    buffer_load_ushort a224, v129, s[36:39], 0 offen offset:0
    v_max_f32 v34, 0x35c1a2a0, v34
    v_exp_f32_e64 v115, v35 clamp
    v_max_f32 v35, 0x35c1a2a0, v35
    v_exp_f32_e64 v116, v36 clamp
    v_max_f32 v36, 0x35c1a2a0, v36
    buffer_load_ushort a225, v129, s[36:39], 0 offen offset:64
    v_exp_f32_e64 v117, v37 clamp
    v_max_f32 v37, 0x35c1a2a0, v37
    v_exp_f32_e64 v118, v38 clamp
    v_max_f32 v38, 0x35c1a2a0, v38
    buffer_load_ushort a226, v129, s[36:39], 0 offen offset:128
    v_exp_f32_e64 v119, v39 clamp
    v_max_f32 v39, 0x35c1a2a0, v39
    v_pk_fma_f32 v[112:113], v[32:33], s[58:59], v[112:113] op_sel_hi:[1,0,1]
    v_pk_fma_f32 v[114:115], v[34:35], s[58:59], v[114:115] op_sel_hi:[1,0,1]
    buffer_load_ushort a227, v129, s[36:39], 0 offen offset:192
    v_pk_fma_f32 v[116:117], v[36:37], s[58:59], v[116:117] op_sel_hi:[1,0,1]
    v_pk_fma_f32 v[118:119], v[38:39], s[58:59], v[118:119] op_sel_hi:[1,0,1]
    v_cvt_pk_bf16_f32 v128, v112, v113
    v_cvt_pk_bf16_f32 v129, v114, v115
    v_cvt_pk_bf16_f32 v130, v116, v117
    v_cvt_pk_bf16_f32 v131, v118, v119
    s_nop 1
    v_mfma_f32_32x32x16_bf16 v[48:63], v[128:131], v[136:139], 0
    s_add_u32 m0, s72, 1024
    s_add_u32 s52, s71, 7168
    buffer_load_dwordx4 v7, s[16:19], s52 offen lds
    v_exp_f32_e64 v120, v40 clamp
    v_max_f32 v40, 0x35c1a2a0, v40
    v_exp_f32_e64 v121, v41 clamp
    v_max_f32 v41, 0x35c1a2a0, v41
    v_exp_f32_e64 v122, v42 clamp
    v_max_f32 v42, 0x35c1a2a0, v42
    v_exp_f32_e64 v123, v43 clamp
    v_max_f32 v43, 0x35c1a2a0, v43
    v_exp_f32_e64 v124, v44 clamp
    v_max_f32 v44, 0x35c1a2a0, v44
    v_exp_f32_e64 v125, v45 clamp
    v_max_f32 v45, 0x35c1a2a0, v45
    v_exp_f32_e64 v126, v46 clamp
    v_max_f32 v46, 0x35c1a2a0, v46
    v_exp_f32_e64 v127, v47 clamp
    v_max_f32 v47, 0x35c1a2a0, v47
    v_pk_fma_f32 v[120:121], v[40:41], s[58:59], v[120:121] op_sel_hi:[1,0,1]
    v_pk_fma_f32 v[122:123], v[42:43], s[58:59], v[122:123] op_sel_hi:[1,0,1]
    v_pk_fma_f32 v[124:125], v[44:45], s[58:59], v[124:125] op_sel_hi:[1,0,1]
    v_pk_fma_f32 v[126:127], v[46:47], s[58:59], v[126:127] op_sel_hi:[1,0,1]
    v_cvt_pk_bf16_f32 v132, v120, v121
    v_cvt_pk_bf16_f32 v133, v122, v123
    v_cvt_pk_bf16_f32 v134, v124, v125
    v_cvt_pk_bf16_f32 v135, v126, v127
    s_add_u32 m0, s72, 2048
    s_add_u32 s52, s71, 14336
    buffer_load_dwordx4 v7, s[16:19], s52 offen lds
    v_mfma_f32_32x32x16_bf16 v[48:63], v[132:135], v[140:143], v[48:63]
    s_cmp_eq_u32 s6, 3
    s_cselect_b32 s53, 1073741824, s67
    v_lshlrev_b32 v83, 2, v1
    v_lshlrev_b32 v2, 4, v1
    v_mov_b32 v3, s7
    v_lshlrev_b32 v6, 3, v1
    v_accvgpr_read_b32 v4, a192
    v_accvgpr_read_b32 v7, a195
    v_accvgpr_read_b32 v5, a196
    v_accvgpr_read_b32 v11, a198
    v_accvgpr_read_b32 v8, a196
    v_accvgpr_read_b32 v13, a201
    ds_write_b128 v86, v[48:51] offset:0
    ds_write_b128 v86, v[52:55] offset:1024
    ds_write_b128 v86, v[56:59] offset:2048
    ds_write_b128 v86, v[60:63] offset:3072
    s_waitcnt vmcnt(17)
    v_cmp_ne_u32 vcc, s7, v102
    s_cbranch_vccz Ldone_2
    s_mov_b32 s56, 0x100000
Lpoll_1:
    buffer_load_dword v102, v101, s[32:35], 0 offen sc1
    s_waitcnt vmcnt(0)
    v_cmp_ne_u32 vcc, s7, v102
    s_cbranch_vccz Ldone_2
    s_sub_u32 s56, s56, 1
    s_cbranch_scc0 Lpoll_1
Ldone_2:
    s_waitcnt lgkmcnt(0)
    s_barrier
    ds_read2st64_b32 v[48:49], v87 offset0:0 offset1:1
    ds_read2st64_b32 v[50:51], v87 offset0:2 offset1:3
    ds_read2st64_b32 v[52:53], v87 offset0:16 offset1:17
    ds_read2st64_b32 v[54:55], v87 offset0:18 offset1:19
    ds_read2st64_b32 v[56:57], v87 offset0:32 offset1:33
    ds_read2st64_b32 v[58:59], v87 offset0:34 offset1:35
    ds_read2st64_b32 v[60:61], v87 offset0:48 offset1:49
    ds_read2st64_b32 v[62:63], v87 offset0:50 offset1:51
    ds_read_b64_tr_b16 a[128:129], v10 offset:0
    ds_read_b64_tr_b16 a[130:131], v10 offset:256
    ds_read_b64_tr_b16 a[132:133], v10 offset:1024
    ds_read_b64_tr_b16 a[134:135], v10 offset:1280
    ds_read_b64_tr_b16 a[136:137], v10 offset:2048
    ds_read_b64_tr_b16 a[138:139], v10 offset:2304
    s_waitcnt lgkmcnt(11)
    v_pk_add_f32 v[48:49], v[48:49], v[52:53]
    s_waitcnt lgkmcnt(10)
    v_pk_add_f32 v[50:51], v[50:51], v[54:55]
    s_waitcnt lgkmcnt(7)
    v_pk_add_f32 v[56:57], v[56:57], v[60:61]
    s_waitcnt lgkmcnt(6)
    v_pk_add_f32 v[58:59], v[58:59], v[62:63]
    v_pk_add_f32 v[48:49], v[48:49], v[56:57]
    v_pk_add_f32 v[50:51], v[50:51], v[58:59]
    buffer_atomic_add_f32 v48, v83, s[32:35], s67 offen offset:0
    buffer_atomic_add_f32 v49, v83, s[32:35], s67 offen offset:256
    buffer_atomic_add_f32 v50, v83, s[32:35], s53 offen offset:512
    buffer_atomic_add_f32 v51, v83, s[32:35], s53 offen offset:768
    s_cmp_ge_u32 s5, 28
    s_cbranch_scc1 L_spare
    ds_read_b64_tr_b16 a[140:141], v10 offset:3072
    ds_read_b64_tr_b16 a[142:143], v10 offset:3328
    ds_read_b64_tr_b16 a[144:145], v10 offset:4096
    ds_read_b64_tr_b16 a[146:147], v10 offset:4352
    ds_read_b64_tr_b16 a[148:149], v10 offset:5120
    ds_read_b64_tr_b16 a[150:151], v10 offset:5376
    s_add_u32 m0, s72, 3072
    s_add_u32 s52, s71, 21504
    buffer_load_dwordx4 v7, s[16:19], s52 offen lds
    s_add_u32 m0, s72, 4096
    s_add_u32 s52, s71, 28672
    buffer_load_dwordx4 v7, s[16:19], s52 offen lds
    s_add_u32 m0, s72, 5120
    s_add_u32 s52, s71, 35840
    buffer_load_dwordx4 v7, s[16:19], s52 offen lds
    s_add_u32 m0, s72, 6144
    s_add_u32 s52, s71, 43008
    buffer_load_dwordx4 v7, s[16:19], s52 offen lds
    s_add_u32 m0, s72, 7168
    s_add_u32 s52, s71, 50176
    buffer_load_dwordx4 v7, s[16:19], s52 offen lds
    s_add_u32 m0, s72, 8192
    s_add_u32 s52, s71, 57344
    buffer_load_dwordx4 v7, s[16:19], s52 offen lds
    s_waitcnt lgkmcnt(10)
    v_mfma_f32_32x32x16_bf16 v[64:79], a[128:131], v[144:147], 0
    ds_read_b64_tr_b16 a[152:153], v10 offset:6144
    ds_read_b64_tr_b16 a[154:155], v10 offset:6400
    v_lshlrev_b32 v85, 11, v1
    v_and_b32 v84, 15, v1
    v_lshl_add_u32 v84, v84, 2, s74
    s_mov_b32 s44, s57
    s_mul_i32 s46, s6, 7
    s_sub_u32 s45, s44, 7
    s_cmp_ge_u32 s44, 7
    s_cselect_b32 s44, s45, s44
    v_add_u32 v87, s65, v10
    v_lshrrev_b32 v104, 5, v1
    v_mul_u32_u24 v104, 384, v104
    s_waitcnt lgkmcnt(10)
    v_mfma_f32_32x32x16_bf16 v[64:79], a[132:135], v[148:151], v[64:79]
    ds_read_b64_tr_b16 a[156:157], v10 offset:7168
    ds_read_b64_tr_b16 a[158:159], v10 offset:7424
    v_accvgpr_read_b32 v86, a202
    v_cndmask_b32_e64 v84, v84, v86, s[48:49]
    s_add_u32 s45, s44, s46
    s_lshl_b32 s36, s45, 10
    v_lshl_add_u32 v104, v1, 2, v104
    v_add_u32 v104, 160768, v104
    s_lshl_b32 s47, s6, 8
    s_add_u32 s47, s47, 160768
    v_lshl_add_u32 v105, v1, 2, s47
    s_waitcnt lgkmcnt(10)
    v_mfma_f32_32x32x16_bf16 v[64:79], a[136:139], v[152:155], v[64:79]
    ds_read_b64_tr_b16 a[160:161], v10 offset:8192
    ds_read_b64_tr_b16 a[162:163], v10 offset:8448
    s_add_u32 m0, s72, 9216
    s_add_u32 s52, s71, 64512
    buffer_load_dwordx4 v7, s[16:19], s52 offen lds
    v_mov_b32 v47, 0
    s_sub_u32 s67, s67, s65
    s_and_b32 s3, s45, 1
    s_mul_i32 s3, s3, 43008
    ds_read_b64_tr_b16 a[64:65], v87 offset:0
    ds_read_b64_tr_b16 a[66:67], v87 offset:256
    s_waitcnt lgkmcnt(12)
    v_mfma_f32_32x32x16_bf16 v[64:79], a[140:143], v[156:159], v[64:79]
    ds_read_b64_tr_b16 a[164:165], v10 offset:9216
    ds_read_b64_tr_b16 a[166:167], v10 offset:9472
    s_mul_i32 s45, s45, 57344
    s_sub_u32 s45, s45, s3
    s_add_u32 s90, s45, s54
    s_add_u32 s44, s44, 1
    s_waitcnt lgkmcnt(12)
    v_mfma_f32_32x32x16_bf16 v[64:79], a[144:147], v[160:163], v[64:79]
    ds_read_b64_tr_b16 a[168:169], v10 offset:10240
    ds_read_b64_tr_b16 a[170:171], v10 offset:10496
    s_add_u32 m0, s72, 10240
    s_add_u32 s52, s71, 71680
    buffer_load_dwordx4 v7, s[16:19], s52 offen lds
    s_sub_u32 s45, s44, 7
    s_cmp_ge_u32 s44, 7
    s_cselect_b32 s44, s45, s44
    ds_read_b64_tr_b16 a[68:69], v87 offset:4096
    ds_read_b64_tr_b16 a[70:71], v87 offset:4352
    s_waitcnt lgkmcnt(14)
    v_mfma_f32_32x32x16_bf16 v[64:79], a[148:151], v[164:167], v[64:79]
    ds_read_b64_tr_b16 a[172:173], v10 offset:11264
    ds_read_b64_tr_b16 a[174:175], v10 offset:11520
    s_add_u32 s45, s44, s46
    s_lshl_b32 s37, s45, 10
    s_waitcnt lgkmcnt(14)
    v_mfma_f32_32x32x16_bf16 v[64:79], a[152:155], v[168:171], v[64:79]
    ds_read_b64_tr_b16 a[176:177], v10 offset:12288
    ds_read_b64_tr_b16 a[178:179], v10 offset:12544
    s_add_u32 m0, s72, 11264
    s_add_u32 s52, s71, 78848
    buffer_load_dwordx4 v7, s[16:19], s52 offen lds
    s_and_b32 s3, s45, 1
    s_mul_i32 s3, s3, 43008
    s_mul_i32 s45, s45, 57344
    s_sub_u32 s45, s45, s3
    v_add_u32 v8, s83, v8
    v_xor_b32 v9, 64, v8
    v_cvt_pk_bf16_f32 v88, -v106, -v106
    v_mov_b32 v89, v88
    s_waitcnt lgkmcnt(10)
    v_mfma_f32_16x16x32_bf16 v[24:27], v[16:19], a[64:67], 0
    ds_read_b64_tr_b16 a[72:73], v87 offset:8192
    ds_read_b64_tr_b16 a[74:75], v87 offset:8448
    v_mfma_f32_32x32x16_bf16 v[64:79], a[156:159], v[172:175], v[64:79]
    ds_read_b64_tr_b16 a[180:181], v10 offset:13312
    ds_read_b64_tr_b16 a[182:183], v10 offset:13568
    s_add_u32 s91, s45, s54
    s_add_u32 s44, s44, 1
    v_accvgpr_read_b32 v28, a193
    v_accvgpr_read_b32 v30, a194
    v_mfma_f32_32x32x16_bf16 v[64:79], a[160:163], v[176:179], v[64:79]
    ds_read_b64_tr_b16 a[184:185], v10 offset:14336
    ds_read_b64_tr_b16 a[186:187], v10 offset:14592
    s_waitcnt vmcnt(9)
    s_barrier
    s_mov_b64 exec, 0xff
    buffer_store_dword v3, v85, s[32:35], s68 offen sc1
    s_mov_b64 exec, -1
    s_add_u32 m0, s72, 12288
    s_add_u32 s52, s71, 86016
    buffer_load_dwordx4 v7, s[16:19], s52 offen lds
    s_sub_u32 s45, s44, 7
    s_cmp_ge_u32 s44, 7
    s_cselect_b32 s44, s45, s44
    v_xor_b32 v29, 64, v28
    s_waitcnt lgkmcnt(10)
    v_mfma_f32_16x16x32_bf16 v[24:27], v[16:19], a[68:71], v[24:27]
    ds_read_b64_tr_b16 a[76:77], v87 offset:12288
    ds_read_b64_tr_b16 a[78:79], v87 offset:12544
    v_mfma_f32_32x32x16_bf16 v[64:79], a[164:167], v[180:183], v[64:79]
    ds_read_b64_tr_b16 a[188:189], v10 offset:15360
    ds_read_b64_tr_b16 a[190:191], v10 offset:15616
    s_add_u32 s45, s44, s46
    s_lshl_b32 s38, s45, 10
    s_and_b32 s3, s45, 1
    s_mul_i32 s3, s3, 43008
    v_xor_b32 v31, 64, v30
    v_accvgpr_read_b32 v20, a204
    v_mfma_f32_32x32x16_bf16 v[64:79], a[168:171], v[184:187], v[64:79]
    ds_read_b64_tr_b16 a[128:129], v10 offset:16384
    ds_read_b64_tr_b16 a[130:131], v10 offset:16640
    s_add_u32 m0, s72, 13312
    s_add_u32 s52, s71, 93184
    buffer_load_dwordx4 v7, s[16:19], s52 offen lds
    s_mul_i32 s45, s45, 57344
    s_sub_u32 s45, s45, s3
    v_accvgpr_read_b32 v21, a205
    v_accvgpr_read_b32 v22, a206
    s_waitcnt lgkmcnt(10)
    v_mfma_f32_16x16x32_bf16 v[24:27], v[16:19], a[72:75], v[24:27]
    ds_read_b64_tr_b16 a[80:81], v87 offset:16384
    ds_read_b64_tr_b16 a[82:83], v87 offset:16640
    v_mfma_f32_32x32x16_bf16 v[64:79], a[172:175], v[188:191], v[64:79]
    ds_read_b64_tr_b16 a[132:133], v10 offset:17408
    ds_read_b64_tr_b16 a[134:135], v10 offset:17664
    s_add_u32 s92, s45, s54
    s_add_u32 s44, s44, 1
    v_accvgpr_read_b32 v23, a207
    v_mfma_f32_32x32x16_bf16 v[64:79], a[176:179], v[192:195], v[64:79]
    ds_read_b64_tr_b16 a[136:137], v10 offset:18432
    ds_read_b64_tr_b16 a[138:139], v10 offset:18688
    s_add_u32 m0, s65, 0
    s_add_u32 s52, s73, 0
    buffer_load_dwordx4 v4, s[20:23], s52 offen lds
    s_sub_u32 s45, s44, 7
    s_cmp_ge_u32 s44, 7
    s_cselect_b32 s44, s45, s44
    s_add_u32 s45, s44, s46
    s_lshl_b32 s39, s45, 10
    s_waitcnt lgkmcnt(10)
    v_mfma_f32_16x16x32_bf16 v[24:27], v[16:19], a[76:79], v[24:27]
    ds_read_b64_tr_b16 a[84:85], v87 offset:20480
    ds_read_b64_tr_b16 a[86:87], v87 offset:20736
    v_mfma_f32_32x32x16_bf16 v[64:79], a[180:183], v[196:199], v[64:79]
    ds_read_b64_tr_b16 a[140:141], v10 offset:19456
    ds_read_b64_tr_b16 a[142:143], v10 offset:19712
    s_and_b32 s3, s45, 1
    s_mul_i32 s3, s3, 43008
    v_mfma_f32_32x32x16_bf16 v[64:79], a[184:187], v[200:203], v[64:79]
    ds_read_b64_tr_b16 a[144:145], v10 offset:20480
    ds_read_b64_tr_b16 a[146:147], v10 offset:20736
    s_add_u32 m0, s65, 4096
    s_add_u32 s52, s73, 114688
    buffer_load_dwordx4 v4, s[20:23], s52 offen lds
    s_mul_i32 s45, s45, 57344
    s_sub_u32 s45, s45, s3
    s_waitcnt lgkmcnt(10)
    v_mfma_f32_16x16x32_bf16 v[24:27], v[16:19], a[80:83], v[24:27]
    ds_read_b64_tr_b16 a[88:89], v87 offset:24576
    ds_read_b64_tr_b16 a[90:91], v87 offset:24832
    v_mfma_f32_32x32x16_bf16 v[64:79], a[188:191], v[204:207], v[64:79]
    ds_read_b64_tr_b16 a[148:149], v10 offset:21504
    ds_read_b64_tr_b16 a[150:151], v10 offset:21760
    s_add_u32 s93, s45, s54
    s_add_u32 s44, s44, 1
    s_sub_u32 s45, s44, 7
    s_cmp_ge_u32 s44, 7
    s_cselect_b32 s44, s45, s44
    v_mfma_f32_32x32x16_bf16 v[64:79], a[128:131], v[208:211], v[64:79]
    ds_read_b64_tr_b16 a[152:153], v10 offset:22528
    ds_read_b64_tr_b16 a[154:155], v10 offset:22784
    s_add_u32 m0, s65, 8192
    s_add_u32 s52, s73, 229376
    buffer_load_dwordx4 v4, s[20:23], s52 offen lds
    s_add_u32 s45, s44, s46
    s_lshl_b32 s40, s45, 10
    s_waitcnt lgkmcnt(10)
    v_mfma_f32_16x16x32_bf16 v[24:27], v[16:19], a[84:87], v[24:27]
    v_mfma_f32_32x32x16_bf16 v[64:79], a[132:135], v[212:215], v[64:79]
    ds_read_b64_tr_b16 a[156:157], v10 offset:23552
    ds_read_b64_tr_b16 a[158:159], v10 offset:23808
    s_and_b32 s3, s45, 1
    s_mul_i32 s3, s3, 43008
    v_mfma_f32_32x32x16_bf16 v[64:79], a[136:139], v[216:219], v[64:79]
    ds_read_b64_tr_b16 a[160:161], v10 offset:24576
    ds_read_b64_tr_b16 a[162:163], v10 offset:24832
    s_add_u32 m0, s65, 12288
    s_add_u32 s52, s73, 344064
    buffer_load_dwordx4 v4, s[20:23], s52 offen lds
    s_mul_i32 s45, s45, 57344
    s_sub_u32 s45, s45, s3
    s_add_u32 s94, s45, s54
    s_add_u32 s44, s44, 1
    s_waitcnt lgkmcnt(8)
    v_mfma_f32_16x16x32_bf16 v[24:27], v[16:19], a[88:91], v[24:27]
    v_mfma_f32_32x32x16_bf16 v[64:79], a[140:143], v[220:223], v[64:79]
    ds_read_b64_tr_b16 a[164:165], v10 offset:25600
    ds_read_b64_tr_b16 a[166:167], v10 offset:25856
    s_sub_u32 s45, s44, 7
    s_cmp_ge_u32 s44, 7
    s_cselect_b32 s44, s45, s44
    v_mfma_f32_32x32x16_bf16 v[64:79], a[144:147], v[224:227], v[64:79]
    ds_read_b64_tr_b16 a[168:169], v10 offset:26624
    ds_read_b64_tr_b16 a[170:171], v10 offset:26880
    s_add_u32 m0, s65, 16384
    s_add_u32 s52, s73, 458752
    buffer_load_dwordx4 v4, s[20:23], s52 offen lds
    s_add_u32 s45, s44, s46
    s_lshl_b32 s41, s45, 10
    v_cvt_pk_bf16_f32 v80, v24, v24
    v_and_b32 v80, 0xffff0000, v80
    v_sub_f32 v92, v24, v80
    s_waitcnt lgkmcnt(10)
    v_mfma_f32_32x32x16_bf16 v[64:79], a[148:151], v[228:231], v[64:79]
    ds_read_b64_tr_b16 a[172:173], v10 offset:27648
    ds_read_b64_tr_b16 a[174:175], v10 offset:27904
    s_and_b32 s3, s45, 1
    s_mul_i32 s3, s3, 43008
    s_mul_i32 s45, s45, 57344
    s_sub_u32 s45, s45, s3
    v_cvt_pk_bf16_f32 v92, v80, v92
    ds_write_b32 v105, v92
    s_waitcnt lgkmcnt(11)
    v_mfma_f32_32x32x16_bf16 v[64:79], a[152:155], v[232:235], v[64:79]
    s_add_u32 m0, s65, 20480
    s_add_u32 s52, s73, 573440
    buffer_load_dwordx4 v4, s[20:23], s52 offen lds
    s_add_u32 s95, s45, s54
    s_add_u32 s44, s44, 1
    s_waitcnt lgkmcnt(9)
    v_mfma_f32_32x32x16_bf16 v[64:79], a[156:159], v[236:239], v[64:79]
    s_sub_u32 s45, s44, 7
    s_cmp_ge_u32 s44, 7
    s_cselect_b32 s44, s45, s44
    s_waitcnt lgkmcnt(7)
    v_mfma_f32_32x32x16_bf16 v[64:79], a[160:163], v[240:243], v[64:79]
    s_add_u32 s45, s44, s46
    s_lshl_b32 s42, s45, 10
    s_and_b32 s3, s45, 1
    s_mul_i32 s3, s3, 43008
    s_waitcnt lgkmcnt(0)
    s_barrier
    ds_read2st64_b32 v[92:93], v104 offset0:0 offset1:1
    v_mfma_f32_32x32x16_bf16 v[64:79], a[164:167], v[244:247], v[64:79]
    s_mul_i32 s45, s45, 57344
    s_sub_u32 s45, s45, s3
    v_mfma_f32_32x32x16_bf16 v[64:79], a[168:171], v[248:251], v[64:79]
    s_add_u32 s96, s45, s54
    s_add_u32 s44, s44, 1
    v_mfma_f32_32x32x16_bf16 v[64:79], a[172:175], v[252:255], v[64:79]
    s_waitcnt lgkmcnt(0)
    v_mfma_f32_32x32x16_bf16 v[64:79], v[92:95], v[88:91], v[64:79]
    s_add_u32 m0, s65, 24576
    s_add_u32 s52, s73, 688128
    buffer_load_dwordx4 v4, s[20:23], s52 offen lds
    s_add_u32 m0, s65, 28672
    s_add_u32 s52, s73, 802816
    buffer_load_dwordx4 v4, s[20:23], s52 offen lds
    s_add_u32 m0, s65, 32768
    s_add_u32 s52, s73, 917504
    buffer_load_dwordx4 v4, s[20:23], s52 offen lds
    s_add_u32 m0, s65, 36864
    s_add_u32 s52, s73, 1032192
    buffer_load_dwordx4 v4, s[20:23], s52 offen lds
    v_pk_mul_f32 v[64:65], v[64:65], v[108:109] op_sel_hi:[1,0]
    v_pk_mul_f32 v[66:67], v[66:67], v[108:109] op_sel_hi:[1,0]
    v_pk_mul_f32 v[68:69], v[68:69], v[108:109] op_sel_hi:[1,0]
    v_pk_mul_f32 v[70:71], v[70:71], v[108:109] op_sel_hi:[1,0]
    v_pk_mul_f32 v[72:73], v[72:73], v[108:109] op_sel_hi:[1,0]
    v_pk_mul_f32 v[74:75], v[74:75], v[108:109] op_sel_hi:[1,0]
    v_pk_mul_f32 v[76:77], v[76:77], v[108:109] op_sel_hi:[1,0]
    v_pk_mul_f32 v[78:79], v[78:79], v[108:109] op_sel_hi:[1,0]
    v_exp_f32_e64 v112, v64 clamp
    v_max_f32 v64, 0x35c1a2a0, v64
    v_exp_f32_e64 v113, v65 clamp
    v_max_f32 v65, 0x35c1a2a0, v65
    v_exp_f32_e64 v114, v66 clamp
    v_max_f32 v66, 0x35c1a2a0, v66
    v_exp_f32_e64 v115, v67 clamp
    v_max_f32 v67, 0x35c1a2a0, v67
    v_exp_f32_e64 v116, v68 clamp
    v_max_f32 v68, 0x35c1a2a0, v68
    v_exp_f32_e64 v117, v69 clamp
    v_max_f32 v69, 0x35c1a2a0, v69
    v_exp_f32_e64 v118, v70 clamp
    v_max_f32 v70, 0x35c1a2a0, v70
    v_exp_f32_e64 v119, v71 clamp
    v_max_f32 v71, 0x35c1a2a0, v71
    buffer_load_dword v102, v84, s[32:35], 0 offen sc1
    v_pk_fma_f32 v[112:113], v[64:65], s[58:59], v[112:113] op_sel_hi:[1,0,1]
    v_pk_fma_f32 v[114:115], v[66:67], s[58:59], v[114:115] op_sel_hi:[1,0,1]
    v_pk_fma_f32 v[116:117], v[68:69], s[58:59], v[116:117] op_sel_hi:[1,0,1]
    v_pk_fma_f32 v[118:119], v[70:71], s[58:59], v[118:119] op_sel_hi:[1,0,1]
    v_cvt_pk_bf16_f32 v128, v112, v113
    v_cvt_pk_bf16_f32 v129, v114, v115
    v_cvt_pk_bf16_f32 v130, v116, v117
    v_cvt_pk_bf16_f32 v131, v118, v119
    v_exp_f32_e64 v120, v72 clamp
    v_max_f32 v72, 0x35c1a2a0, v72
    v_exp_f32_e64 v121, v73 clamp
    v_max_f32 v73, 0x35c1a2a0, v73
    v_exp_f32_e64 v122, v74 clamp
    v_max_f32 v74, 0x35c1a2a0, v74
    v_exp_f32_e64 v123, v75 clamp
    v_max_f32 v75, 0x35c1a2a0, v75
    v_exp_f32_e64 v124, v76 clamp
    v_max_f32 v76, 0x35c1a2a0, v76
    v_exp_f32_e64 v125, v77 clamp
    v_max_f32 v77, 0x35c1a2a0, v77
    v_exp_f32_e64 v126, v78 clamp
    v_max_f32 v78, 0x35c1a2a0, v78
    v_exp_f32_e64 v127, v79 clamp
    v_max_f32 v79, 0x35c1a2a0, v79
    v_pk_fma_f32 v[120:121], v[72:73], s[58:59], v[120:121] op_sel_hi:[1,0,1]
    v_pk_fma_f32 v[122:123], v[74:75], s[58:59], v[122:123] op_sel_hi:[1,0,1]
    v_pk_fma_f32 v[124:125], v[76:77], s[58:59], v[124:125] op_sel_hi:[1,0,1]
    v_pk_fma_f32 v[126:127], v[78:79], s[58:59], v[126:127] op_sel_hi:[1,0,1]
    v_cvt_pk_bf16_f32 v132, v120, v121
    v_cvt_pk_bf16_f32 v133, v122, v123
    v_cvt_pk_bf16_f32 v134, v124, v125
    v_cvt_pk_bf16_f32 v135, v126, v127
    s_waitcnt vmcnt(11)
    s_barrier
    s_add_u32 m0, s65, 40960
    s_add_u32 s52, s73, 1146880
    buffer_load_dwordx4 v4, s[20:23], s52 offen lds
    s_add_u32 m0, s65, 45056
    s_add_u32 s52, s73, 1261568
    buffer_load_dwordx4 v4, s[20:23], s52 offen lds
    s_waitcnt vmcnt(2)
    v_and_b32 v103, -8, v102
    v_cmp_ne_u32 vcc, s7, v103
    s_cbranch_vccz Ldone_4
    s_mov_b32 s56, 0x100000
Lpoll_3:
    buffer_load_dword v102, v84, s[32:35], 0 offen sc1
    s_waitcnt vmcnt(0)
    v_and_b32 v103, -8, v102
    v_cmp_ne_u32 vcc, s7, v103
    s_cbranch_vccz Ldone_4
    s_sub_u32 s56, s56, 1
    s_cbranch_scc0 Lpoll_3
Ldone_4:
    buffer_load_dwordx4 v[48:51], v2, s[32:35], s67 offen offset:0 sc1
    buffer_load_dwordx4 v[52:55], v2, s[32:35], s67 offen offset:1024 sc1
    buffer_load_dwordx4 v[56:59], v2, s[32:35], s67 offen offset:2048 sc1
    buffer_load_dwordx4 v[60:63], v2, s[32:35], s67 offen offset:3072 sc1
    v_cmp_ne_u32 vcc, s60, v102
    s_nop 0
    s_cmp_eq_u32 vcc_lo, 0
    s_cselect_b32 s57, 1, 0
    s_cbranch_scc0 L_slowtail
    ds_read_b64_tr_b16 a[0:1], v28 offset:0
    ds_read_b64_tr_b16 a[2:3], v28 offset:512
    ds_read_b64_tr_b16 a[4:5], v29 offset:0
    ds_read_b64_tr_b16 a[6:7], v29 offset:512
    ds_read_b64_tr_b16 a[8:9], v28 offset:1024
    ds_read_b64_tr_b16 a[10:11], v30 offset:1536
    ds_read_b64_tr_b16 a[12:13], v29 offset:1024
    ds_read_b64_tr_b16 a[14:15], v31 offset:1536
    ds_read_b64_tr_b16 a[16:17], v28 offset:7168
    ds_read_b64_tr_b16 a[18:19], v28 offset:7680
    ds_read_b64_tr_b16 a[20:21], v29 offset:7168
    ds_read_b64_tr_b16 a[22:23], v29 offset:7680
    ds_read_b64_tr_b16 a[24:25], v28 offset:8192
    ds_read_b64_tr_b16 a[26:27], v30 offset:8704
    ds_read_b64_tr_b16 a[28:29], v29 offset:8192
    ds_read_b64_tr_b16 a[30:31], v31 offset:8704
    ds_read_b64_tr_b16 a[32:33], v28 offset:14336
    ds_read_b64_tr_b16 a[34:35], v28 offset:14848
    ds_read_b64_tr_b16 a[36:37], v29 offset:14336
    ds_read_b64_tr_b16 a[38:39], v29 offset:14848
    ds_read_b64_tr_b16 a[40:41], v28 offset:15360
    ds_read_b64_tr_b16 a[42:43], v30 offset:15872
    s_add_u32 m0, s65, 49152
    s_add_u32 s52, s73, 1376256
    buffer_load_dwordx4 v4, s[20:23], s52 offen lds
    ds_read_b64_tr_b16 a[44:45], v29 offset:15360
    ds_read_b64_tr_b16 a[46:47], v31 offset:15872
    ds_read_b64_tr_b16 a[48:49], v28 offset:21504
    ds_read_b64_tr_b16 a[50:51], v28 offset:22016
    ds_read_b64_tr_b16 a[52:53], v29 offset:21504
    ds_read_b64_tr_b16 a[54:55], v29 offset:22016
    ds_read_b64_tr_b16 a[56:57], v28 offset:22528
    ds_read_b64_tr_b16 a[58:59], v30 offset:23040
    ds_read_b64_tr_b16 a[60:61], v29 offset:22528
    ds_read_b64_tr_b16 a[62:63], v31 offset:23040
    s_mul_i32 s3, s79, 7168
    s_sub_u32 s3, s3, 3584
    v_add_u32 v28, s3, v28
    v_add_u32 v29, s3, v29
    v_add_u32 v30, s3, v30
    v_add_u32 v31, s3, v31
    ds_read_b64_tr_b16 a[64:65], v28 offset:0
    ds_read_b64_tr_b16 a[66:67], v28 offset:512
    ds_read_b64_tr_b16 a[68:69], v29 offset:0
    ds_read_b64_tr_b16 a[70:71], v29 offset:512
    ds_read_b64_tr_b16 a[72:73], v28 offset:1024
    ds_read_b64_tr_b16 a[74:75], v30 offset:1536
    ds_read_b64_tr_b16 a[76:77], v29 offset:1024
    ds_read_b64_tr_b16 a[78:79], v31 offset:1536
    ds_read_b64_tr_b16 a[80:81], v28 offset:7168
    ds_read_b64_tr_b16 a[82:83], v28 offset:7680
    ds_read_b64_tr_b16 a[84:85], v29 offset:7168
    s_add_u32 m0, s65, 53248
    s_add_u32 s52, s73, 1490944
    buffer_load_dwordx4 v4, s[20:23], s52 offen lds
    ds_read_b64_tr_b16 a[86:87], v29 offset:7680
    ds_read_b64_tr_b16 a[88:89], v28 offset:8192
    ds_read_b64_tr_b16 a[90:91], v30 offset:8704
    ds_read_b64_tr_b16 a[92:93], v29 offset:8192
    ds_read_b64_tr_b16 a[94:95], v31 offset:8704
    ds_read_b64_tr_b16 a[96:97], v28 offset:14336
    ds_read_b64_tr_b16 a[98:99], v28 offset:14848
    ds_read_b64_tr_b16 a[100:101], v29 offset:14336
    ds_read_b64_tr_b16 a[102:103], v29 offset:14848
    ds_read_b64_tr_b16 a[104:105], v28 offset:15360
    ds_read_b64_tr_b16 a[106:107], v30 offset:15872
    ds_read_b64_tr_b16 a[108:109], v29 offset:15360
    ds_read_b64_tr_b16 a[110:111], v31 offset:15872
    ds_read_b64_tr_b16 a[112:113], v28 offset:21504
    ds_read_b64_tr_b16 a[114:115], v28 offset:22016
    ds_read_b64_tr_b16 a[116:117], v29 offset:21504
    ds_read_b64_tr_b16 a[118:119], v29 offset:22016
    ds_read_b64_tr_b16 a[120:121], v28 offset:22528
    ds_read_b64_tr_b16 a[122:123], v30 offset:23040
    ds_read_b64_tr_b16 a[124:125], v29 offset:22528
    ds_read_b64_tr_b16 a[126:127], v31 offset:23040
    s_add_u32 m0, s83, 4096
    v_add_u32 v15, 6144, v7
    buffer_load_dwordx4 v7, s[24:27], s90 offen lds
    buffer_load_dwordx4 v15, s[24:27], s90 offen offset:1024 lds
    s_waitcnt vmcnt(7)
    v_cvt_pk_bf16_f32 v48, v48, v49
    v_cvt_pk_bf16_f32 v49, v50, v51
    s_waitcnt vmcnt(6)
    v_cvt_pk_bf16_f32 v50, v52, v53
    v_cvt_pk_bf16_f32 v51, v54, v55
    s_waitcnt vmcnt(5)
    v_cvt_pk_bf16_f32 v52, v56, v57
    v_cvt_pk_bf16_f32 v53, v58, v59
    s_waitcnt vmcnt(4)
    v_cvt_pk_bf16_f32 v54, v60, v61
    v_cvt_pk_bf16_f32 v55, v62, v63
    v_mfma_f32_32x32x16_bf16 v[64:79], v[48:51], v[128:131], 0
    s_nop 0
    v_mfma_f32_32x32x16_bf16 v[64:79], v[52:55], v[132:135], v[64:79]
    s_nop 11
    v_add_f32 v78, 0x358637bd, v78
    v_rcp_f32 v78, v78
    s_nop 0
    v_pk_mul_f32 v[64:65], v[64:65], v[78:79] op_sel_hi:[1,0]
    v_pk_mul_f32 v[66:67], v[66:67], v[78:79] op_sel_hi:[1,0]
    v_pk_mul_f32 v[68:69], v[68:69], v[78:79] op_sel_hi:[1,0]
    v_pk_mul_f32 v[70:71], v[70:71], v[78:79] op_sel_hi:[1,0]
    v_pk_mul_f32 v[72:73], v[72:73], v[78:79] op_sel_hi:[1,0]
    v_pk_mul_f32 v[74:75], v[74:75], v[78:79] op_sel_hi:[1,0]
    v_pk_mul_f32 v[76:77], v[76:77], v[78:79] op_sel_hi:[1,0]
    v_cvt_pk_bf16_f32 v40, v64, v65
    v_cvt_pk_bf16_f32 v41, v66, v67
    v_cvt_pk_bf16_f32 v42, v68, v69
    v_cvt_pk_bf16_f32 v43, v70, v71
    v_cvt_pk_bf16_f32 v44, v72, v73
    v_cvt_pk_bf16_f32 v45, v74, v75
    v_cvt_pk_bf16_f32 v46, v76, v77
    buffer_store_dwordx4 v[40:43], v2, s[32:35], s69 offen
    buffer_store_dwordx4 v[44:47], v2, s[32:35], s69 offen offset:1024
    v_accvgpr_read_b32 v248, a208
    v_accvgpr_read_b32 v249, a209
    v_accvgpr_read_b32 v250, a210
    v_accvgpr_read_b32 v251, a211
    v_accvgpr_read_b32 v252, a212
    v_accvgpr_read_b32 v253, a213
    v_accvgpr_read_b32 v254, a214
    v_accvgpr_read_b32 v255, a215
    v_accvgpr_read_b32 v10, a199
    v_accvgpr_read_b32 v177, a216
    v_lshlrev_b32 v176, 16, v177
    v_and_b32 v177, 0xffff0000, v177
    v_accvgpr_read_b32 v179, a217
    v_lshlrev_b32 v178, 16, v179
    v_and_b32 v179, 0xffff0000, v179
    v_accvgpr_read_b32 v181, a218
    v_lshlrev_b32 v180, 16, v181
    v_and_b32 v181, 0xffff0000, v181
    v_accvgpr_read_b32 v183, a219
    v_lshlrev_b32 v182, 16, v183
    v_and_b32 v183, 0xffff0000, v183
    v_accvgpr_read_b32 v185, a220
    v_lshlrev_b32 v184, 16, v185
    v_and_b32 v185, 0xffff0000, v185
    v_accvgpr_read_b32 v187, a221
    v_lshlrev_b32 v186, 16, v187
    v_and_b32 v187, 0xffff0000, v187
    v_accvgpr_read_b32 v189, a222
    v_lshlrev_b32 v188, 16, v189
    v_and_b32 v189, 0xffff0000, v189
    v_accvgpr_read_b32 v191, a223
    v_lshlrev_b32 v190, 16, v191
    v_and_b32 v191, 0xffff0000, v191
    v_add_u32 v240, 57344, v20
    v_add_u32 v241, 57344, v21
    v_add_u32 v242, 57344, v22
    v_add_u32 v243, 57344, v23
    s_add_u32 m0, s83, 6144
    s_nop 0
    buffer_load_dwordx4 v7, s[24:27], s91 offen lds
    buffer_load_dwordx4 v15, s[24:27], s91 offen offset:1024 lds
    s_lshr_b32 s3, s6, 1
    s_mul_i32 s3, s3, 28672
    v_add_u32 v244, s3, v5
    s_and_b32 s3, s6, 1
    s_lshl_b32 s3, s3, 6
    v_xor_b32 v172, s3, v5
    v_xor_b32 v173, 64, v172
    v_add_u32 v174, 57344, v172
    v_add_u32 v175, 57344, v173
    s_sub_u32 s3, s72, 57344
    v_add_u32 v5, s3, v5
    v_xor_b32 v14, 64, v5
    v_accvgpr_read_b32 v153, a224
    v_mov_b32 v154, 0
    v_mov_b32 v155, 0
    v_accvgpr_read_b32 v157, a225
    v_mov_b32 v158, 0
    v_mov_b32 v159, 0
    v_accvgpr_read_b32 v161, a226
    v_mov_b32 v162, 0
    v_mov_b32 v163, 0
    v_accvgpr_read_b32 v165, a227
    v_mov_b32 v166, 0
    v_mov_b32 v167, 0
    v_mov_b32 v170, 0
    v_mov_b32 v171, 0
    v_mov_b32 v246, 0x3f803f80
    s_or_b32 s60, s7, 1
    v_mov_b32 v247, s60
    s_mul_i32 s3, s79, 14336
    s_add_u32 s54, s76, s3
    s_add_u32 s54, s54, 2048
    s_xor_b32 s55, s54, 2048
    v_and_b32 v245, 7, v1
    v_lshlrev_b32 v245, 2, v245
    s_cmp_eq_u32 s79, 0
    s_mov_b32 s44, 0xaaaaaaaa
    s_cselect_b32 s44, s44, 0x55555555
    s_mov_b32 s45, s44
    s_add_u32 m0, s83, 8192
    s_nop 0
    buffer_load_dwordx4 v7, s[24:27], s92 offen lds
    buffer_load_dwordx4 v15, s[24:27], s92 offen offset:1024 lds
    s_waitcnt vmcnt(4)
    s_mov_b64 exec, 1
    buffer_store_dword v3, off, s[32:35], s70
    s_mov_b64 exec, -1
    s_waitcnt lgkmcnt(0)
    s_barrier
    s_sub_u32 s72, s72, 57344
    v_lshlrev_b32 v81, 4, v1
    v_lshlrev_b32 v82, 2, v1
    buffer_store_dwordx4 v[16:19], v81, s[32:35], s80 offen sc1
    buffer_store_dwordx4 v[16:19], v81, s[32:35], s80 offen offset:1024 sc1
    buffer_store_dword v16, v82, s[32:35], s81 offen sc1
    s_add_u32 m0, s65, 57344
    s_add_u32 s52, s73, 128
    buffer_load_dwordx4 v4, s[20:23], s52 offen lds
    s_add_u32 m0, s65, 61440
    s_add_u32 s52, s73, 114816
    buffer_load_dwordx4 v4, s[20:23], s52 offen lds
    s_mov_b32 s56, 0x100000
Lpoll_5:
    buffer_load_dword v12, v245, s[32:35], s75 offen sc1
    s_waitcnt vmcnt(0)
    v_cmp_ne_u32 vcc, s7, v12
    s_cbranch_vccz Ldone_6
    s_sub_u32 s56, s56, 1
    s_cbranch_scc0 Lpoll_5
Ldone_6:
    buffer_load_dwordx4 v[88:91], v2, s[32:35], s54 offen offset:0 sc1
    buffer_load_dwordx4 v[92:95], v2, s[32:35], s54 offen offset:1024 sc1
    s_add_u32 s54, s54, 4096
    buffer_load_dwordx4 v[96:99], v2, s[32:35], s54 offen offset:0 sc1
    buffer_load_dwordx4 v[100:103], v2, s[32:35], s54 offen offset:1024 sc1
    s_add_u32 s54, s54, 4096
    buffer_load_dwordx4 v[104:107], v2, s[32:35], s54 offen offset:0 sc1
    buffer_load_dwordx4 v[108:111], v2, s[32:35], s54 offen offset:1024 sc1
    s_add_u32 s54, s54, 4096
    buffer_load_dwordx4 v[112:115], v2, s[32:35], s54 offen offset:0 sc1
    buffer_load_dwordx4 v[116:119], v2, s[32:35], s54 offen offset:1024 sc1
    buffer_load_dwordx4 v[120:123], v2, s[32:35], s55 offen offset:0 sc1
    buffer_load_dwordx4 v[124:127], v2, s[32:35], s55 offen offset:1024 sc1
    s_add_u32 s55, s55, 4096
    buffer_load_dwordx4 v[128:131], v2, s[32:35], s55 offen offset:0 sc1
    buffer_load_dwordx4 v[132:135], v2, s[32:35], s55 offen offset:1024 sc1
    s_add_u32 s55, s55, 4096
    ds_read_b64_tr_b16 a[128:129], v8 offset:4096
    ds_read_b64_tr_b16 a[130:131], v8 offset:5120
    ds_read_b64_tr_b16 a[132:133], v9 offset:4096
    ds_read_b64_tr_b16 a[134:135], v9 offset:5120
    ds_read_b64_tr_b16 a[136:137], v8 offset:6144
    ds_read_b64_tr_b16 a[138:139], v8 offset:7168
    ds_read_b64_tr_b16 a[140:141], v9 offset:6144
    ds_read_b64_tr_b16 a[142:143], v9 offset:7168
    ds_read_b64_tr_b16 a[144:145], v8 offset:8192
    ds_read_b64_tr_b16 a[146:147], v8 offset:9216
    ds_read_b64_tr_b16 a[148:149], v9 offset:8192
    ds_read_b64_tr_b16 a[150:151], v9 offset:9216
    s_waitcnt vmcnt(11)
    v_mfma_f32_32x32x16_bf16 v[176:191], a[0:3], v[88:91], v[176:191]
    buffer_load_dwordx4 v[136:139], v2, s[32:35], s55 offen offset:0 sc1
    buffer_load_dwordx4 v[140:143], v2, s[32:35], s55 offen offset:1024 sc1
    s_add_u32 s55, s55, 4096
    v_mfma_f32_32x32x16_bf16 v[192:207], a[4:7], v[88:91], 0
    s_waitcnt vmcnt(12)
    v_mfma_f32_32x32x16_bf16 v[176:191], a[8:11], v[92:95], v[176:191]
    buffer_load_dwordx4 v[144:147], v2, s[32:35], s55 offen offset:0 sc1
    buffer_load_dwordx4 v[148:151], v2, s[32:35], s55 offen offset:1024 sc1
    v_mfma_f32_32x32x16_bf16 v[192:207], a[12:15], v[92:95], v[192:207]
    s_waitcnt vmcnt(13)
    v_mfma_f32_32x32x16_bf16 v[176:191], a[16:19], v[96:99], v[176:191]
    v_mfma_f32_32x32x16_bf16 v[192:207], a[20:23], v[96:99], v[192:207]
    s_waitcnt vmcnt(12)
    v_mfma_f32_32x32x16_bf16 v[176:191], a[24:27], v[100:103], v[176:191]
    v_mfma_f32_32x32x16_bf16 v[192:207], a[28:31], v[100:103], v[192:207]
    s_waitcnt vmcnt(11)
    v_mfma_f32_32x32x16_bf16 v[176:191], a[32:35], v[104:107], v[176:191]
    v_mfma_f32_32x32x16_bf16 v[192:207], a[36:39], v[104:107], v[192:207]
    s_waitcnt vmcnt(10)
    v_mfma_f32_32x32x16_bf16 v[176:191], a[40:43], v[108:111], v[176:191]
    v_mfma_f32_32x32x16_bf16 v[192:207], a[44:47], v[108:111], v[192:207]
    s_waitcnt vmcnt(9)
    v_mfma_f32_32x32x16_bf16 v[176:191], a[48:51], v[112:115], v[176:191]
    v_mfma_f32_32x32x16_bf16 v[192:207], a[52:55], v[112:115], v[192:207]
    s_waitcnt vmcnt(8)
    v_mfma_f32_32x32x16_bf16 v[176:191], a[56:59], v[116:119], v[176:191]
    v_mfma_f32_32x32x16_bf16 v[192:207], a[60:63], v[116:119], v[192:207]
    s_waitcnt vmcnt(7)
    v_mfma_f32_32x32x16_bf16 v[176:191], a[64:67], v[120:123], v[176:191]
    v_lshlrev_b32 v82, 5, v1
    buffer_load_dword v87, v82, s[32:35], s80 offen sc1
    v_mfma_f32_32x32x16_bf16 v[192:207], a[68:71], v[120:123], v[192:207]
    v_lshlrev_b32 v82, 2, v1
    buffer_load_dword v87, v82, s[32:35], s81 offen sc1
    s_waitcnt vmcnt(8)
    v_mfma_f32_32x32x16_bf16 v[176:191], a[72:75], v[124:127], v[176:191]
    v_mfma_f32_32x32x16_bf16 v[192:207], a[76:79], v[124:127], v[192:207]
    s_add_u32 m0, s65, 65536
    s_add_u32 s52, s73, 229504
    buffer_load_dwordx4 v4, s[20:23], s52 offen lds
    s_waitcnt vmcnt(8)
    v_mfma_f32_32x32x16_bf16 v[192:207], a[84:87], v[128:131], v[192:207]
    s_waitcnt vmcnt(7)
    v_mfma_f32_32x32x16_bf16 v[192:207], a[92:95], v[132:135], v[192:207]
    s_add_u32 m0, s65, 69632
    s_add_u32 s52, s73, 344192
    buffer_load_dwordx4 v4, s[20:23], s52 offen lds
    s_waitcnt vmcnt(7)
    v_mfma_f32_32x32x16_bf16 v[192:207], a[100:103], v[136:139], v[192:207]
    s_add_u32 m0, s65, 73728
    s_add_u32 s52, s73, 458880
    buffer_load_dwordx4 v4, s[20:23], s52 offen lds
    s_waitcnt vmcnt(7)
    v_mfma_f32_32x32x16_bf16 v[192:207], a[108:111], v[140:143], v[192:207]
    s_waitcnt vmcnt(6)
    v_mfma_f32_32x32x16_bf16 v[192:207], a[116:119], v[144:147], v[192:207]
    s_add_u32 m0, s65, 77824
    s_add_u32 s52, s73, 573568
    buffer_load_dwordx4 v4, s[20:23], s52 offen lds
    s_waitcnt vmcnt(6)
    v_mfma_f32_32x32x16_bf16 v[192:207], a[124:127], v[148:151], v[192:207]
    v_mfma_f32_32x32x16_bf16 v[176:191], a[80:83], v[128:131], v[176:191]
    v_mfma_f32_32x32x16_bf16 v[176:191], a[88:91], v[132:135], v[176:191]
    v_mfma_f32_32x32x16_bf16 v[176:191], a[96:99], v[136:139], v[176:191]
    s_nop 8
    ds_write_b128 v240, v[192:195] offset:0
    v_mfma_f32_32x32x16_bf16 v[176:191], a[104:107], v[140:143], v[176:191]
    ds_write_b128 v240, v[196:199] offset:1024
    v_mfma_f32_32x32x16_bf16 v[176:191], a[112:115], v[144:147], v[176:191]
    ds_write_b128 v240, v[200:203] offset:2048
    v_mfma_f32_32x32x16_bf16 v[176:191], a[120:123], v[148:151], v[176:191]
    ds_write_b128 v240, v[204:207] offset:3072
    s_waitcnt lgkmcnt(0)
    s_barrier
    ds_read_b128 v[24:27], v243 offset:0
    ds_read_b128 v[28:31], v243 offset:1024
    ds_read_b128 v[32:35], v243 offset:2048
    ds_read_b128 v[36:39], v243 offset:3072
    s_waitcnt lgkmcnt(3)
    s_nop 3
    v_pk_add_f32 v[176:177], v[176:177], v[24:25]
    v_pk_add_f32 v[178:179], v[178:179], v[26:27]
    v_cvt_pk_bf16_f32 v72, v176, v177
    v_cvt_pk_bf16_f32 v73, v178, v179
    s_waitcnt lgkmcnt(2)
    v_pk_add_f32 v[180:181], v[180:181], v[28:29]
    v_pk_add_f32 v[182:183], v[182:183], v[30:31]
    v_cvt_pk_bf16_f32 v74, v180, v181
    v_cvt_pk_bf16_f32 v75, v182, v183
    s_waitcnt lgkmcnt(1)
    v_pk_add_f32 v[184:185], v[184:185], v[32:33]
    v_pk_add_f32 v[186:187], v[186:187], v[34:35]
    v_cvt_pk_bf16_f32 v76, v184, v185
    v_cvt_pk_bf16_f32 v77, v186, v187
    s_waitcnt lgkmcnt(0)
    v_pk_add_f32 v[188:189], v[188:189], v[36:37]
    v_pk_add_f32 v[190:191], v[190:191], v[38:39]
    v_cvt_pk_bf16_f32 v78, v188, v189
    v_cvt_pk_bf16_f32 v79, v190, v191
    buffer_store_dwordx4 v[72:75], v2, s[32:35], s80 offen
    buffer_store_dwordx4 v[76:79], v2, s[32:35], s80 offen offset:1024
    ds_read_b64_tr_b16 a[0:1], v244 offset:0
    ds_read_b64_tr_b16 a[2:3], v244 offset:1024
    ds_read_b64_tr_b16 a[4:5], v244 offset:2048
    ds_read_b64_tr_b16 a[6:7], v244 offset:3072
    ds_read_b64_tr_b16 a[8:9], v244 offset:4096
    ds_read_b64_tr_b16 a[10:11], v244 offset:5120
    v_dot2_f32_bf16 v80, v72, v246, 0
    v_dot2_f32_bf16 v81, v72, v72, 0
    v_dot2_f32_bf16 v80, v73, v246, v80
    v_dot2_f32_bf16 v81, v73, v73, v81
    v_dot2_f32_bf16 v80, v74, v246, v80
    v_dot2_f32_bf16 v81, v74, v74, v81
    v_dot2_f32_bf16 v80, v75, v246, v80
    v_dot2_f32_bf16 v81, v75, v75, v81
    v_dot2_f32_bf16 v80, v76, v246, v80
    v_dot2_f32_bf16 v81, v76, v76, v81
    v_dot2_f32_bf16 v80, v77, v246, v80
    v_dot2_f32_bf16 v81, v77, v77, v81
    v_dot2_f32_bf16 v80, v78, v246, v80
    v_dot2_f32_bf16 v81, v78, v78, v81
    v_dot2_f32_bf16 v80, v79, v246, v80
    v_dot2_f32_bf16 v81, v79, v79, v81
    v_mov_b32 v86, v247
    ds_read_b64_tr_b16 a[12:13], v244 offset:6144
    ds_read_b64_tr_b16 a[14:15], v244 offset:7168
    v_mov_b32 v82, v80
    v_mov_b32 v83, v81
    ds_read_b64_tr_b16 a[16:17], v244 offset:8192
    ds_read_b64_tr_b16 a[18:19], v244 offset:9216
    v_permlane32_swap_b32 v80, v82
    v_permlane32_swap_b32 v81, v83
    v_pk_add_f32 v[80:81], v[80:81], v[82:83]
    s_mov_b64 exec, s[48:49]
    buffer_store_dwordx2 v[80:81], v6, s[32:35], s81 offen
    s_mov_b64 exec, -1
    ds_read_b64_tr_b16 a[20:21], v244 offset:10240
    ds_read_b64_tr_b16 a[22:23], v244 offset:11264
    v_mov_b32 v28, v244
    v_add_u32 v29, 57344, v244
    s_waitcnt lgkmcnt(10)
    v_mfma_f32_16x16x32_bf16 v[24:27], v[16:19], a[0:3], 0
    ds_read_b64_tr_b16 a[24:25], v28 offset:12288
    ds_read_b64_tr_b16 a[26:27], v28 offset:13312
    v_mov_b32 v240, v72
    v_mov_b32 v241, v73
    s_waitcnt lgkmcnt(10)
    v_mfma_f32_16x16x32_bf16 v[24:27], v[16:19], a[4:7], v[24:27]
    ds_read_b64_tr_b16 a[28:29], v28 offset:14336
    ds_read_b64_tr_b16 a[30:31], v28 offset:15360
    v_mov_b32 v242, v74
    s_add_u32 m0, s65, 81920
    s_add_u32 s52, s73, 688256
    buffer_load_dwordx4 v4, s[20:23], s52 offen lds
    s_waitcnt lgkmcnt(10)
    v_mfma_f32_16x16x32_bf16 v[24:27], v[16:19], a[8:11], v[24:27]
    ds_read_b64_tr_b16 a[0:1], v28 offset:16384
    ds_read_b64_tr_b16 a[2:3], v28 offset:17408
    v_mov_b32 v243, v75
    v_mov_b32 v244, v76
    s_waitcnt lgkmcnt(10)
    v_mfma_f32_16x16x32_bf16 v[24:27], v[16:19], a[12:15], v[24:27]
    ds_read_b64_tr_b16 a[4:5], v28 offset:18432
    ds_read_b64_tr_b16 a[6:7], v28 offset:19456
    s_add_u32 m0, s65, 86016
    s_add_u32 s52, s73, 802944
    buffer_load_dwordx4 v4, s[20:23], s52 offen lds
    v_mov_b32 v245, v77
    s_waitcnt lgkmcnt(10)
    v_mfma_f32_16x16x32_bf16 v[24:27], v[16:19], a[16:19], v[24:27]
    ds_read_b64_tr_b16 a[8:9], v28 offset:20480
    ds_read_b64_tr_b16 a[10:11], v28 offset:21504
    v_mov_b32 v246, v78
    s_add_u32 m0, s65, 90112
    s_add_u32 s52, s73, 917632
    buffer_load_dwordx4 v4, s[20:23], s52 offen lds
    s_waitcnt vmcnt(4)
    s_mov_b64 exec, 1
    buffer_store_dword v3, off, s[32:35], s82
    s_mov_b64 exec, -1
    s_waitcnt lgkmcnt(10)
    v_mfma_f32_16x16x32_bf16 v[24:27], v[16:19], a[20:23], v[24:27]
    ds_read_b64_tr_b16 a[12:13], v28 offset:22528
    ds_read_b64_tr_b16 a[14:15], v28 offset:23552
    v_mov_b32 v247, v79
    v_and_b32 v30, 15, v1
    s_waitcnt lgkmcnt(10)
    v_mfma_f32_16x16x32_bf16 v[24:27], v[16:19], a[24:27], v[24:27]
    ds_read_b64_tr_b16 a[16:17], v28 offset:24576
    ds_read_b64_tr_b16 a[18:19], v28 offset:25600
    s_add_u32 m0, s65, 94208
    s_add_u32 s52, s73, 1032320
    buffer_load_dwordx4 v4, s[20:23], s52 offen lds
    s_waitcnt lgkmcnt(10)
    v_mfma_f32_16x16x32_bf16 v[24:27], v[16:19], a[28:31], v[24:27]
    ds_read_b64_tr_b16 a[20:21], v28 offset:26624
    ds_read_b64_tr_b16 a[22:23], v28 offset:27648
    v_min_u32 v30, 13, v30
    v_lshlrev_b32 v30, 2, v30
    s_waitcnt lgkmcnt(10)
    v_mfma_f32_16x16x32_bf16 v[24:27], v[16:19], a[0:3], v[24:27]
    s_lshl_b32 s53, s84, 6
    s_add_u32 s53, s53, 24576
    s_add_u32 m0, s65, 98304
    s_add_u32 s52, s73, 1147008
    buffer_load_dwordx4 v4, s[20:23], s52 offen lds
    s_waitcnt lgkmcnt(8)
    v_mfma_f32_16x16x32_bf16 v[24:27], v[16:19], a[4:7], v[24:27]
    s_lshl_b32 s55, s84, 12
    s_add_u32 s55, s55, 131072
    v_lshl_add_u32 v31, v1, 2, s83
    s_waitcnt lgkmcnt(6)
    v_mfma_f32_16x16x32_bf16 v[24:27], v[16:19], a[8:11], v[24:27]
    s_add_u32 m0, s65, 102400
    s_add_u32 s52, s73, 1261696
    buffer_load_dwordx4 v4, s[20:23], s52 offen lds
    v_lshrrev_b32 v32, 5, v1
    s_waitcnt lgkmcnt(4)
    v_mfma_f32_16x16x32_bf16 v[24:27], v[16:19], a[12:15], v[24:27]
    v_mul_u32_u24 v32, 24576, v32
    s_add_u32 m0, s65, 106496
    s_add_u32 s52, s73, 1376384
    buffer_load_dwordx4 v4, s[20:23], s52 offen lds
    s_waitcnt lgkmcnt(2)
    v_mfma_f32_16x16x32_bf16 v[24:27], v[16:19], a[16:19], v[24:27]
    v_lshl_add_u32 v32, v1, 2, v32
    v_add_u32 v32, 124928, v32
    s_waitcnt lgkmcnt(0)
    v_mfma_f32_16x16x32_bf16 v[24:27], v[16:19], a[20:23], v[24:27]
    s_add_u32 m0, s65, 110592
    s_add_u32 s52, s73, 1491072
    buffer_load_dwordx4 v4, s[20:23], s52 offen lds
    s_waitcnt vmcnt(9)
    s_mov_b64 exec, 1
    buffer_store_dword v86, off, s[32:35], s82
    s_mov_b64 exec, -1
    buffer_load_dword v84, v30, s[32:35], s53 offen sc1
    s_add_u32 m0, s83, 0
    s_nop 0
    buffer_load_dwordx4 v7, s[24:27], s93 offen lds
    buffer_load_dwordx4 v15, s[24:27], s93 offen offset:1024 lds
    s_add_u32 m0, s83, 2048
    s_nop 0
    buffer_load_dwordx4 v7, s[24:27], s94 offen lds
    buffer_load_dwordx4 v15, s[24:27], s94 offen offset:1024 lds
    v_cvt_pk_bf16_f32 v34, v24, v24
    v_and_b32 v34, 0xffff0000, v34
    v_sub_f32 v33, v24, v34
    v_cvt_pk_bf16_f32 v33, v34, v33
    ds_write_b32 v31, v33 offset:10240
    ds_read_b64_tr_b16 a[88:89], v172 offset:0
    ds_read_b64_tr_b16 a[90:91], v172 offset:1024
    ds_read_b64_tr_b16 a[92:93], v173 offset:0
    ds_read_b64_tr_b16 a[94:95], v173 offset:1024
    ds_read_b64_tr_b16 a[96:97], v172 offset:2048
    ds_read_b64_tr_b16 a[98:99], v172 offset:3072
    ds_read_b64_tr_b16 a[100:101], v173 offset:2048
    ds_read_b64_tr_b16 a[102:103], v173 offset:3072
    ds_read_b64_tr_b16 a[104:105], v172 offset:4096
    ds_read_b64_tr_b16 a[106:107], v172 offset:5120
    ds_read_b64_tr_b16 a[108:109], v173 offset:4096
    ds_read_b64_tr_b16 a[110:111], v173 offset:5120
    ds_read_b64_tr_b16 a[112:113], v172 offset:6144
    ds_read_b64_tr_b16 a[114:115], v172 offset:7168
    ds_read_b64_tr_b16 a[116:117], v173 offset:6144
    ds_read_b64_tr_b16 a[118:119], v173 offset:7168
    ds_read_b64_tr_b16 a[120:121], v172 offset:8192
    ds_read_b64_tr_b16 a[122:123], v172 offset:9216
    ds_read_b64_tr_b16 a[124:125], v173 offset:8192
    ds_read_b64_tr_b16 a[126:127], v173 offset:9216
    s_waitcnt vmcnt(4)
    v_and_b32 v85, -8, v84
    v_cmp_ne_u32 vcc, s7, v85
    s_cbranch_vccz Ldone_8
    s_mov_b32 s56, 0x100000
Lpoll_7:
    buffer_load_dword v84, v30, s[32:35], s53 offen sc1
    s_waitcnt vmcnt(0)
    v_and_b32 v85, -8, v84
    v_cmp_ne_u32 vcc, s7, v85
    s_cbranch_vccz Ldone_8
    s_sub_u32 s56, s56, 1
    s_cbranch_scc0 Lpoll_7
Ldone_8:
    buffer_load_dwordx4 v[40:43], v2, s[32:35], s85 offen offset:0 sc1
    buffer_load_dwordx4 v[44:47], v2, s[32:35], s85 offen offset:1024 sc1
    buffer_load_dwordx4 v[48:51], v2, s[32:35], s85 offen offset:2048 sc1
    buffer_load_dwordx4 v[52:55], v2, s[32:35], s85 offen offset:3072 sc1
    s_add_u32 s85, s85, 4096
    buffer_load_dwordx4 v[56:59], v2, s[32:35], s85 offen offset:0 sc1
    buffer_load_dwordx4 v[60:63], v2, s[32:35], s85 offen offset:1024 sc1
    buffer_load_dwordx4 v[64:67], v2, s[32:35], s85 offen offset:2048 sc1
    buffer_load_dwordx4 v[68:71], v2, s[32:35], s85 offen offset:3072 sc1
    s_add_u32 s85, s85, 4096
    buffer_load_dword v12, v30, s[32:35], s53 offen sc1
    s_waitcnt lgkmcnt(15)
    s_barrier
    ds_read_b32 v152, v32 offset:0
    ds_read_b32 v156, v32 offset:12288
    ds_read_b64_tr_b16 a[24:25], v29 offset:0
    ds_read_b64_tr_b16 a[26:27], v29 offset:1024
    ds_read_b64_tr_b16 a[28:29], v29 offset:2048
    ds_read_b64_tr_b16 a[30:31], v29 offset:3072
    ds_read_b64_tr_b16 a[0:1], v29 offset:4096
    ds_read_b64_tr_b16 a[2:3], v29 offset:5120
    ds_read_b64_tr_b16 a[4:5], v29 offset:6144
    ds_read_b64_tr_b16 a[6:7], v29 offset:7168
    ds_read_b64_tr_b16 a[8:9], v29 offset:8192
    ds_read_b64_tr_b16 a[10:11], v29 offset:9216
    ds_read_b64_tr_b16 a[12:13], v29 offset:10240
    ds_read_b64_tr_b16 a[14:15], v29 offset:11264
    s_waitcnt lgkmcnt(10)
    v_mfma_f32_16x16x32_bf16 v[24:27], v[16:19], a[24:27], 0
    ds_read_b64_tr_b16 a[16:17], v29 offset:12288
    ds_read_b64_tr_b16 a[18:19], v29 offset:13312
    s_waitcnt lgkmcnt(10)
    v_mfma_f32_16x16x32_bf16 v[24:27], v[16:19], a[28:31], v[24:27]
    ds_read_b64_tr_b16 a[20:21], v29 offset:14336
    ds_read_b64_tr_b16 a[22:23], v29 offset:15360
    s_waitcnt lgkmcnt(10)
    v_mfma_f32_16x16x32_bf16 v[24:27], v[16:19], a[0:3], v[24:27]
    ds_read_b64_tr_b16 a[24:25], v29 offset:16384
    ds_read_b64_tr_b16 a[26:27], v29 offset:17408
    s_waitcnt lgkmcnt(10)
    v_mfma_f32_16x16x32_bf16 v[24:27], v[16:19], a[4:7], v[24:27]
    ds_read_b64_tr_b16 a[28:29], v29 offset:18432
    ds_read_b64_tr_b16 a[30:31], v29 offset:19456
    s_waitcnt lgkmcnt(10)
    v_mfma_f32_16x16x32_bf16 v[24:27], v[16:19], a[8:11], v[24:27]
    ds_read_b64_tr_b16 a[0:1], v29 offset:20480
    ds_read_b64_tr_b16 a[2:3], v29 offset:21504
    s_waitcnt lgkmcnt(10)
    v_mfma_f32_16x16x32_bf16 v[24:27], v[16:19], a[12:15], v[24:27]
    ds_read_b64_tr_b16 a[4:5], v29 offset:22528
    ds_read_b64_tr_b16 a[6:7], v29 offset:23552
    s_waitcnt lgkmcnt(10)
    v_mfma_f32_16x16x32_bf16 v[24:27], v[16:19], a[16:19], v[24:27]
    ds_read_b64_tr_b16 a[8:9], v29 offset:24576
    ds_read_b64_tr_b16 a[10:11], v29 offset:25600
    s_waitcnt lgkmcnt(10)
    v_mfma_f32_16x16x32_bf16 v[24:27], v[16:19], a[20:23], v[24:27]
    ds_read_b64_tr_b16 a[12:13], v29 offset:26624
    ds_read_b64_tr_b16 a[14:15], v29 offset:27648
    s_waitcnt lgkmcnt(10)
    v_mfma_f32_16x16x32_bf16 v[24:27], v[16:19], a[24:27], v[24:27]
    s_waitcnt vmcnt(11)
    ds_read_b64_tr_b16 a[152:153], v8 offset:0
    ds_read_b64_tr_b16 a[154:155], v8 offset:1024
    s_waitcnt lgkmcnt(10)
    v_mfma_f32_16x16x32_bf16 v[24:27], v[16:19], a[28:31], v[24:27]
    ds_read_b64_tr_b16 a[156:157], v9 offset:0
    ds_read_b64_tr_b16 a[158:159], v9 offset:1024
    s_waitcnt lgkmcnt(10)
    v_mfma_f32_16x16x32_bf16 v[24:27], v[16:19], a[0:3], v[24:27]
    s_waitcnt vmcnt(9)
    ds_read_b64_tr_b16 a[160:161], v8 offset:2048
    ds_read_b64_tr_b16 a[162:163], v8 offset:3072
    s_waitcnt lgkmcnt(10)
    v_mfma_f32_16x16x32_bf16 v[24:27], v[16:19], a[4:7], v[24:27]
    ds_read_b64_tr_b16 a[164:165], v9 offset:2048
    ds_read_b64_tr_b16 a[166:167], v9 offset:3072
    s_waitcnt lgkmcnt(10)
    v_mfma_f32_16x16x32_bf16 v[24:27], v[16:19], a[8:11], v[24:27]
    s_waitcnt lgkmcnt(8)
    v_mfma_f32_16x16x32_bf16 v[24:27], v[16:19], a[12:15], v[24:27]
    s_waitcnt vmcnt(8)
    v_mfma_f32_32x32x16_bf16 v[208:223], a[88:91], v[40:43], 0
    ds_read_b64_tr_b16 a[240:241], v172 offset:10240
    ds_read_b64_tr_b16 a[242:243], v172 offset:11264
    ds_read_b64_tr_b16 a[244:245], v173 offset:10240
    ds_read_b64_tr_b16 a[246:247], v173 offset:11264
    v_mfma_f32_32x32x16_bf16 v[224:239], a[92:95], v[40:43], 0
    buffer_load_dwordx4 v[72:75], v2, s[32:35], s85 offen offset:0 sc1
    ds_read_b64_tr_b16 a[248:249], v172 offset:12288
    ds_read_b64_tr_b16 a[250:251], v172 offset:13312
    s_waitcnt vmcnt(8)
    v_mfma_f32_32x32x16_bf16 v[208:223], a[96:99], v[44:47], v[208:223]
    ds_read_b64_tr_b16 a[252:253], v173 offset:12288
    ds_read_b64_tr_b16 a[254:255], v173 offset:13312
    v_mfma_f32_32x32x16_bf16 v[224:239], a[100:103], v[44:47], v[224:239]
    buffer_load_dwordx4 v[76:79], v2, s[32:35], s85 offen offset:1024 sc1
    ds_read_b64_tr_b16 a[88:89], v172 offset:14336
    ds_read_b64_tr_b16 a[90:91], v172 offset:15360
    s_waitcnt vmcnt(8)
    v_mfma_f32_32x32x16_bf16 v[208:223], a[104:107], v[48:51], v[208:223]
    ds_read_b64_tr_b16 a[92:93], v173 offset:14336
    ds_read_b64_tr_b16 a[94:95], v173 offset:15360
    v_mfma_f32_32x32x16_bf16 v[224:239], a[108:111], v[48:51], v[224:239]
    buffer_load_dwordx4 v[80:83], v2, s[32:35], s85 offen offset:2048 sc1
    ds_read_b64_tr_b16 a[96:97], v172 offset:16384
    ds_read_b64_tr_b16 a[98:99], v172 offset:17408
    s_waitcnt vmcnt(8)
    v_mfma_f32_32x32x16_bf16 v[208:223], a[112:115], v[52:55], v[208:223]
    ds_read_b64_tr_b16 a[100:101], v173 offset:16384
    ds_read_b64_tr_b16 a[102:103], v173 offset:17408
    v_mfma_f32_32x32x16_bf16 v[224:239], a[116:119], v[52:55], v[224:239]
    buffer_load_dwordx4 v[84:87], v2, s[32:35], s85 offen offset:3072 sc1
    s_add_u32 s85, s85, 4096
    ds_read_b64_tr_b16 a[104:105], v172 offset:18432
    ds_read_b64_tr_b16 a[106:107], v172 offset:19456
    s_waitcnt vmcnt(8)
    v_mfma_f32_32x32x16_bf16 v[208:223], a[120:123], v[56:59], v[208:223]
    ds_read_b64_tr_b16 a[108:109], v173 offset:18432
    ds_read_b64_tr_b16 a[110:111], v173 offset:19456
    v_mfma_f32_32x32x16_bf16 v[224:239], a[124:127], v[56:59], v[224:239]
    buffer_load_dwordx4 v[88:91], v2, s[32:35], s85 offen offset:0 sc1
    ds_read_b64_tr_b16 a[112:113], v172 offset:20480
    ds_read_b64_tr_b16 a[114:115], v172 offset:21504
    s_waitcnt vmcnt(8) lgkmcnt(15)
    v_mfma_f32_32x32x16_bf16 v[208:223], a[240:243], v[60:63], v[208:223]
    s_waitcnt vmcnt(5)
    v_cmp_ne_u32 vcc, s60, v12
    s_cbranch_vccz Ldone_10
    s_mov_b32 s56, 0x100000
Lpoll_9:
    buffer_load_dword v12, v30, s[32:35], s53 offen sc1
    s_waitcnt vmcnt(0)
    v_cmp_ne_u32 vcc, s60, v12
    s_cbranch_vccz Ldone_10
    s_sub_u32 s56, s56, 1
    s_cbranch_scc0 Lpoll_9
Ldone_10:
    buffer_load_dwordx2 v[194:195], v6, s[32:35], s55 offen offset:0 sc1
    v_mfma_f32_32x32x16_bf16 v[224:239], a[244:247], v[60:63], v[224:239]
    buffer_load_dwordx4 v[92:95], v2, s[32:35], s85 offen offset:1024 sc1
    v_cvt_pk_bf16_f32 v34, v24, v24
    v_and_b32 v34, 0xffff0000, v34
    s_waitcnt lgkmcnt(14)
    v_mfma_f32_32x32x16_bf16 v[208:223], a[248:251], v[64:67], v[208:223]
    buffer_load_dwordx2 v[196:197], v6, s[32:35], s55 offen offset:512 sc1
    v_sub_f32 v33, v24, v34
    v_cvt_pk_bf16_f32 v33, v34, v33
    ds_write_b32 v31, v33 offset:10496
    v_mfma_f32_32x32x16_bf16 v[224:239], a[252:255], v[64:67], v[224:239]
    buffer_load_dwordx4 v[96:99], v2, s[32:35], s85 offen offset:2048 sc1
    ds_read_b64_tr_b16 a[116:117], v173 offset:20480
    ds_read_b64_tr_b16 a[118:119], v173 offset:21504
    s_waitcnt lgkmcnt(13)
    v_mfma_f32_32x32x16_bf16 v[208:223], a[88:91], v[68:71], v[208:223]
    buffer_load_dwordx2 v[198:199], v6, s[32:35], s55 offen offset:1024 sc1
    ds_read_b64_tr_b16 a[120:121], v172 offset:22528
    ds_read_b64_tr_b16 a[122:123], v172 offset:23552
    v_mfma_f32_32x32x16_bf16 v[224:239], a[92:95], v[68:71], v[224:239]
    buffer_load_dwordx4 v[100:103], v2, s[32:35], s85 offen offset:3072 sc1
    s_add_u32 s85, s85, 4096
    ds_read_b64_tr_b16 a[124:125], v173 offset:22528
    ds_read_b64_tr_b16 a[126:127], v173 offset:23552
    s_waitcnt vmcnt(10) lgkmcnt(13)
    v_mfma_f32_32x32x16_bf16 v[208:223], a[96:99], v[72:75], v[208:223]
    buffer_load_dwordx2 v[200:201], v6, s[32:35], s55 offen offset:1536 sc1
    ds_read_b64_tr_b16 a[240:241], v172 offset:24576
    ds_read_b64_tr_b16 a[242:243], v172 offset:25600
    v_mfma_f32_32x32x16_bf16 v[224:239], a[100:103], v[72:75], v[224:239]
    buffer_load_dwordx4 v[104:107], v2, s[32:35], s85 offen offset:0 sc1
    ds_read_b64_tr_b16 a[244:245], v173 offset:24576
    ds_read_b64_tr_b16 a[246:247], v173 offset:25600
    s_waitcnt vmcnt(11) lgkmcnt(13)
    v_mfma_f32_32x32x16_bf16 v[208:223], a[104:107], v[76:79], v[208:223]
    buffer_load_dwordx2 v[202:203], v6, s[32:35], s55 offen offset:2048 sc1
    ds_read_b64_tr_b16 a[248:249], v172 offset:26624
    ds_read_b64_tr_b16 a[250:251], v172 offset:27648
    v_mfma_f32_32x32x16_bf16 v[224:239], a[108:111], v[76:79], v[224:239]
    buffer_load_dwordx4 v[108:111], v2, s[32:35], s85 offen offset:1024 sc1
    ds_read_b64_tr_b16 a[252:253], v173 offset:26624
    ds_read_b64_tr_b16 a[254:255], v173 offset:27648
    s_waitcnt vmcnt(12) lgkmcnt(12)
    v_mfma_f32_32x32x16_bf16 v[208:223], a[112:115], v[80:83], v[208:223]
    buffer_load_dwordx2 v[204:205], v6, s[32:35], s55 offen offset:2560 sc1
    ds_read_b64_tr_b16 a[88:89], v172 offset:28672
    ds_read_b64_tr_b16 a[90:91], v172 offset:29696
    v_mfma_f32_32x32x16_bf16 v[224:239], a[116:119], v[80:83], v[224:239]
    buffer_load_dwordx4 v[112:115], v2, s[32:35], s85 offen offset:2048 sc1
    ds_read_b64_tr_b16 a[92:93], v173 offset:28672
    ds_read_b64_tr_b16 a[94:95], v173 offset:29696
    s_waitcnt vmcnt(13) lgkmcnt(12)
    v_mfma_f32_32x32x16_bf16 v[208:223], a[120:123], v[84:87], v[208:223]
    buffer_load_dwordx2 v[206:207], v6, s[32:35], s55 offen offset:3072 sc1
    ds_read_b64_tr_b16 a[96:97], v172 offset:30720
    ds_read_b64_tr_b16 a[98:99], v172 offset:31744
    v_mfma_f32_32x32x16_bf16 v[224:239], a[124:127], v[84:87], v[224:239]
    buffer_load_dwordx4 v[116:119], v2, s[32:35], s85 offen offset:3072 sc1
    s_add_u32 s85, s85, 4096
    ds_read_b64_tr_b16 a[100:101], v173 offset:30720
    ds_read_b64_tr_b16 a[102:103], v173 offset:31744
    s_waitcnt vmcnt(14) lgkmcnt(12)
    v_mfma_f32_32x32x16_bf16 v[208:223], a[240:243], v[88:91], v[208:223]
    ds_read_b64_tr_b16 a[104:105], v172 offset:32768
    ds_read_b64_tr_b16 a[106:107], v172 offset:33792
    ds_read_b64_tr_b16 a[108:109], v173 offset:32768
    ds_read_b64_tr_b16 a[110:111], v173 offset:33792
    ds_read_b64_tr_b16 a[112:113], v172 offset:34816
    ds_read_b64_tr_b16 a[114:115], v172 offset:35840
    v_mfma_f32_32x32x16_bf16 v[224:239], a[244:247], v[88:91], v[224:239]
    buffer_load_dwordx4 v[120:123], v2, s[32:35], s85 offen offset:0 sc1
    ds_read_b64_tr_b16 a[116:117], v173 offset:34816
    ds_read_b64_tr_b16 a[118:119], v173 offset:35840
    s_waitcnt vmcnt(13) lgkmcnt(15)
    v_mfma_f32_32x32x16_bf16 v[208:223], a[248:251], v[92:95], v[208:223]
    ds_read_b64_tr_b16 a[120:121], v172 offset:36864
    ds_read_b64_tr_b16 a[122:123], v172 offset:37888
    ds_read_b64_tr_b16 a[124:125], v173 offset:36864
    ds_read_b64_tr_b16 a[126:127], v173 offset:37888
    v_mfma_f32_32x32x16_bf16 v[224:239], a[252:255], v[92:95], v[224:239]
    buffer_load_dwordx4 v[124:127], v2, s[32:35], s85 offen offset:1024 sc1
    ds_read_b64_tr_b16 a[240:241], v172 offset:38912
    ds_read_b64_tr_b16 a[242:243], v172 offset:39936
    s_waitcnt vmcnt(12) lgkmcnt(15)
    v_mfma_f32_32x32x16_bf16 v[208:223], a[88:91], v[96:99], v[208:223]
    ds_read_b64_tr_b16 a[244:245], v173 offset:38912
    ds_read_b64_tr_b16 a[246:247], v173 offset:39936
    v_mfma_f32_32x32x16_bf16 v[224:239], a[92:95], v[96:99], v[224:239]
    buffer_load_dwordx4 v[128:131], v2, s[32:35], s85 offen offset:2048 sc1
    ds_read_b64_tr_b16 a[248:249], v172 offset:40960
    ds_read_b64_tr_b16 a[250:251], v172 offset:41984
    s_waitcnt vmcnt(11) lgkmcnt(15)
    v_mfma_f32_32x32x16_bf16 v[208:223], a[96:99], v[100:103], v[208:223]
    ds_read_b64_tr_b16 a[252:253], v173 offset:40960
    ds_read_b64_tr_b16 a[254:255], v173 offset:41984
    v_mfma_f32_32x32x16_bf16 v[224:239], a[100:103], v[100:103], v[224:239]
    buffer_load_dwordx4 v[132:135], v2, s[32:35], s85 offen offset:3072 sc1
    s_add_u32 s85, s85, 4096
    ds_read_b64_tr_b16 a[88:89], v172 offset:43008
    ds_read_b64_tr_b16 a[90:91], v172 offset:44032
    s_waitcnt vmcnt(10) lgkmcnt(15)
    v_mfma_f32_32x32x16_bf16 v[208:223], a[104:107], v[104:107], v[208:223]
    ds_read_b64_tr_b16 a[92:93], v173 offset:43008
    ds_read_b64_tr_b16 a[94:95], v173 offset:44032
    v_mfma_f32_32x32x16_bf16 v[224:239], a[108:111], v[104:107], v[224:239]
    buffer_load_dwordx4 v[136:139], v2, s[32:35], s85 offen offset:0 sc1
    ds_read_b64_tr_b16 a[96:97], v172 offset:45056
    ds_read_b64_tr_b16 a[98:99], v172 offset:46080
    s_waitcnt vmcnt(9) lgkmcnt(15)
    v_mfma_f32_32x32x16_bf16 v[208:223], a[112:115], v[108:111], v[208:223]
    v_add_f32 v194, v194, v196
    v_add_f32 v195, v195, v197
    v_add_f32 v194, v194, v198
    v_add_f32 v195, v195, v199
    v_add_f32 v194, v194, v200
    v_add_f32 v195, v195, v201
    v_mfma_f32_32x32x16_bf16 v[224:239], a[116:119], v[108:111], v[224:239]
    buffer_load_dwordx4 v[140:143], v2, s[32:35], s85 offen offset:1024 sc1
    v_add_f32 v194, v194, v202
    v_add_f32 v195, v195, v203
    s_waitcnt vmcnt(8) lgkmcnt(14)
    v_mfma_f32_32x32x16_bf16 v[208:223], a[120:123], v[112:115], v[208:223]
    v_add_f32 v194, v194, v204
    v_add_f32 v195, v195, v205
    s_waitcnt vmcnt(7)
    v_add_f32 v194, v194, v206
    v_add_f32 v195, v195, v207
    v_mov_b32 v196, v194
    v_mov_b32 v197, v195
    v_mfma_f32_32x32x16_bf16 v[224:239], a[124:127], v[112:115], v[224:239]
    buffer_load_dwordx4 v[144:147], v2, s[32:35], s85 offen offset:2048 sc1
    v_permlane32_swap_b32 v194, v196
    v_permlane32_swap_b32 v195, v197
    s_waitcnt vmcnt(7) lgkmcnt(10)
    v_mfma_f32_32x32x16_bf16 v[208:223], a[240:243], v[116:119], v[208:223]
    v_add_f32 v194, v194, v196
    v_add_f32 v195, v195, v197
    v_mul_f32 v196, 0x3b124925, v194
    v_mul_f32 v198, 0x3b124925, v195
    v_fma_f32 v198, -v196, v196, v198
    v_max_f32 v198, 0, v198
    v_mfma_f32_32x32x16_bf16 v[224:239], a[244:247], v[116:119], v[224:239]
    buffer_load_dwordx4 v[148:151], v2, s[32:35], s85 offen offset:3072 sc1
    s_add_u32 s85, s85, 4096
    v_cvt_pk_bf16_f32 v198, v198, v198
    v_and_b32 v198, 0xffff0000, v198
    s_waitcnt vmcnt(7) lgkmcnt(6)
    v_mfma_f32_32x32x16_bf16 v[208:223], a[248:251], v[120:123], v[208:223]
    ds_read_b64_tr_b16 a[100:101], v173 offset:45056
    ds_read_b64_tr_b16 a[102:103], v173 offset:46080
    v_add_f32 v198, 0x3727c5ac, v198
    v_cvt_pk_bf16_f32 v198, v198, v198
    v_and_b32 v198, 0xffff0000, v198
    v_mfma_f32_32x32x16_bf16 v[224:239], a[252:255], v[120:123], v[224:239]
    ds_read_b64_tr_b16 a[104:105], v172 offset:47104
    ds_read_b64_tr_b16 a[106:107], v172 offset:48128
    v_sqrt_f32 v198, v198
    s_nop 0
    v_cvt_pk_bf16_f32 v198, v198, v198
    v_and_b32 v197, 0xffff0000, v198
    s_waitcnt vmcnt(6) lgkmcnt(6)
    v_mfma_f32_32x32x16_bf16 v[208:223], a[88:91], v[124:127], v[208:223]
    ds_read_b64_tr_b16 a[108:109], v173 offset:47104
    ds_read_b64_tr_b16 a[110:111], v173 offset:48128
    v_rcp_f32 v199, v197
    v_cvt_pk_bf16_f32 v168, -v196, -v196
    v_lshrrev_b32 v197, 16, v197
    v_mfma_f32_32x32x16_bf16 v[224:239], a[92:95], v[124:127], v[224:239]
    ds_read_b64_tr_b16 a[112:113], v172 offset:49152
    ds_read_b64_tr_b16 a[114:115], v172 offset:50176
    v_cndmask_b32_e64 v169, 0, v197, s[48:49]
    v_mul_f32 v199, v199, v199
    ds_write_b32 v31, v199 offset:10752
    s_waitcnt vmcnt(5) lgkmcnt(7)
    v_mfma_f32_32x32x16_bf16 v[208:223], a[96:99], v[128:131], v[208:223]
    ds_read_b64_tr_b16 a[116:117], v173 offset:49152
    ds_read_b64_tr_b16 a[118:119], v173 offset:50176
    ds_read_b64_tr_b16 a[120:121], v172 offset:51200
    ds_read_b64_tr_b16 a[122:123], v172 offset:52224
    ds_read_b64_tr_b16 a[124:125], v173 offset:51200
    ds_read_b64_tr_b16 a[126:127], v173 offset:52224
    v_mfma_f32_32x32x16_bf16 v[224:239], a[100:103], v[128:131], v[224:239]
    s_add_u32 m0, s83, 4096
    s_nop 0
    buffer_load_dwordx4 v7, s[24:27], s95 offen lds
    ds_read_b64_tr_b16 a[240:241], v172 offset:53248
    ds_read_b64_tr_b16 a[242:243], v172 offset:54272
    s_waitcnt vmcnt(5) lgkmcnt(11)
    v_mfma_f32_32x32x16_bf16 v[208:223], a[104:107], v[132:135], v[208:223]
    buffer_load_dwordx4 v15, s[24:27], s95 offen offset:1024 lds
    ds_read_b64_tr_b16 a[244:245], v173 offset:53248
    ds_read_b64_tr_b16 a[246:247], v173 offset:54272
    v_mfma_f32_32x32x16_bf16 v[224:239], a[108:111], v[132:135], v[224:239]
    s_add_u32 m0, s83, 6144
    s_nop 0
    buffer_load_dwordx4 v7, s[24:27], s96 offen lds
    ds_read_b64_tr_b16 a[248:249], v172 offset:55296
    ds_read_b64_tr_b16 a[250:251], v172 offset:56320
    s_waitcnt vmcnt(6) lgkmcnt(10)
    v_mfma_f32_32x32x16_bf16 v[208:223], a[112:115], v[136:139], v[208:223]
    buffer_load_dwordx4 v15, s[24:27], s96 offen offset:1024 lds
    ds_read_b64_tr_b16 a[252:253], v173 offset:55296
    ds_read_b64_tr_b16 a[254:255], v173 offset:56320
    v_mfma_f32_32x32x16_bf16 v[224:239], a[116:119], v[136:139], v[224:239]
    s_add_u32 m0, s83, 8192
    v_add_u32 v7, 28672, v7
    v_add_u32 v15, 6144, v7
    buffer_load_dwordx4 v7, s[24:27], s90 offen lds
    ds_read_b64_tr_b16 a[88:89], v174 offset:0
    ds_read_b64_tr_b16 a[90:91], v174 offset:1024
    s_waitcnt vmcnt(7) lgkmcnt(10)
    v_mfma_f32_32x32x16_bf16 v[208:223], a[120:123], v[140:143], v[208:223]
    buffer_load_dwordx4 v15, s[24:27], s90 offen offset:1024 lds
    ds_read_b64_tr_b16 a[92:93], v174 offset:2048
    ds_read_b64_tr_b16 a[94:95], v174 offset:3072
    ds_read_b64_tr_b16 a[96:97], v174 offset:4096
    ds_read_b64_tr_b16 a[98:99], v174 offset:5120
    v_mfma_f32_32x32x16_bf16 v[224:239], a[124:127], v[140:143], v[224:239]
    s_add_u32 m0, s83, 0
    s_nop 0
    buffer_load_dwordx4 v7, s[24:27], s91 offen lds
    ds_read_b64_tr_b16 a[100:101], v174 offset:6144
    ds_read_b64_tr_b16 a[102:103], v174 offset:7168
    ds_read_b64_tr_b16 a[104:105], v174 offset:8192
    ds_read_b64_tr_b16 a[106:107], v174 offset:9216
    s_waitcnt vmcnt(8) lgkmcnt(14)
    v_mfma_f32_32x32x16_bf16 v[208:223], a[240:243], v[144:147], v[208:223]
    buffer_load_dwordx4 v15, s[24:27], s91 offen offset:1024 lds
    ds_read_b64_tr_b16 a[108:109], v174 offset:10240
    ds_read_b64_tr_b16 a[110:111], v174 offset:11264
    ds_read_b64_tr_b16 a[112:113], v174 offset:12288
    ds_read_b64_tr_b16 a[114:115], v174 offset:13312
    v_mfma_f32_32x32x16_bf16 v[224:239], a[244:247], v[144:147], v[224:239]
    s_add_u32 m0, s83, 2048
    s_nop 0
    buffer_load_dwordx4 v7, s[24:27], s92 offen lds
    ds_read_b64_tr_b16 a[116:117], v174 offset:14336
    ds_read_b64_tr_b16 a[118:119], v174 offset:15360
    ds_read_b64_tr_b16 a[120:121], v174 offset:16384
    ds_read_b64_tr_b16 a[122:123], v174 offset:17408
    s_waitcnt vmcnt(9) lgkmcnt(15)
    v_mfma_f32_32x32x16_bf16 v[208:223], a[248:251], v[148:151], v[208:223]
    v_mfma_f32_32x32x16_bf16 v[208:223], v[152:155], v[168:171], v[208:223]
    s_barrier
    ds_read_b32 v160, v32 offset:256
    ds_read_b32 v164, v32 offset:12544
    buffer_load_dwordx4 v15, s[24:27], s92 offen offset:1024 lds
    v_mfma_f32_32x32x16_bf16 v[224:239], a[252:255], v[148:151], v[224:239]
    v_mfma_f32_32x32x16_bf16 v[224:239], v[156:159], v[168:171], v[224:239]
    s_add_u32 m0, s72, 0
    s_nop 0
    buffer_load_dwordx4 v7, s[24:27], s93 offen lds
    ds_read_b64_tr_b16 a[124:125], v174 offset:18432
    ds_read_b64_tr_b16 a[126:127], v174 offset:19456
    ds_read_b64_tr_b16 a[240:241], v174 offset:20480
    ds_read_b64_tr_b16 a[242:243], v174 offset:21504
    s_waitcnt lgkmcnt(15)
    v_mfma_f32_32x32x16_bf16 v[176:191], a[88:91], v[40:43], 0
    buffer_load_dwordx4 v15, s[24:27], s93 offen offset:1024 lds
    ds_read_b64_tr_b16 a[244:245], v174 offset:22528
    ds_read_b64_tr_b16 a[246:247], v174 offset:23552
    v_mfma_f32_32x32x16_bf16 v[176:191], a[92:95], v[44:47], v[176:191]
    v_mul_f32_e64 v208, v208, |v208|
    v_mul_f32_e64 v209, v209, |v209|
    v_cvt_pk_bf16_f32 v208, v208, v209
    v_pk_max_i16 v208, v208, 0
    v_mul_f32_e64 v210, v210, |v210|
    v_mul_f32_e64 v211, v211, |v211|
    v_cvt_pk_bf16_f32 v209, v210, v211
    v_pk_max_i16 v209, v209, 0
    v_mul_f32_e64 v212, v212, |v212|
    v_mul_f32_e64 v213, v213, |v213|
    v_cvt_pk_bf16_f32 v210, v212, v213
    v_pk_max_i16 v210, v210, 0
    v_mul_f32_e64 v214, v214, |v214|
    v_mul_f32_e64 v215, v215, |v215|
    v_cvt_pk_bf16_f32 v211, v214, v215
    v_pk_max_i16 v211, v211, 0
    v_mul_f32_e64 v216, v216, |v216|
    v_mul_f32_e64 v217, v217, |v217|
    v_cvt_pk_bf16_f32 v212, v216, v217
    v_pk_max_i16 v212, v212, 0
    v_mul_f32_e64 v218, v218, |v218|
    v_mul_f32_e64 v219, v219, |v219|
    v_cvt_pk_bf16_f32 v213, v218, v219
    v_pk_max_i16 v213, v213, 0
    v_mul_f32_e64 v220, v220, |v220|
    v_mul_f32_e64 v221, v221, |v221|
    v_mfma_f32_32x32x16_bf16 v[176:191], a[96:99], v[48:51], v[176:191]
    v_cvt_pk_bf16_f32 v214, v220, v221
    v_pk_max_i16 v214, v214, 0
    v_mul_f32_e64 v222, v222, |v222|
    v_mul_f32_e64 v223, v223, |v223|
    v_cvt_pk_bf16_f32 v215, v222, v223
    v_pk_max_i16 v215, v215, 0
    ds_read_b64_tr_b16 a[248:249], v174 offset:24576
    ds_read_b64_tr_b16 a[250:251], v174 offset:25600
    v_mfma_f32_32x32x16_bf16 v[176:191], a[100:103], v[52:55], v[176:191]
    s_add_u32 s54, s87, 0
    buffer_store_dwordx4 v[208:211], v2, s[32:35], s54 offen offset:0 nt
    buffer_store_dwordx4 v[212:215], v2, s[32:35], s54 offen offset:1024 nt
    s_waitcnt lgkmcnt(15)
    v_mfma_f32_32x32x16_bf16 v[176:191], a[104:107], v[56:59], v[176:191]
    v_mul_f32_e64 v224, v224, |v224|
    v_mul_f32_e64 v225, v225, |v225|
    v_cvt_pk_bf16_f32 v224, v224, v225
    v_pk_max_i16 v224, v224, 0
    v_mul_f32_e64 v226, v226, |v226|
    v_mul_f32_e64 v227, v227, |v227|
    v_cvt_pk_bf16_f32 v225, v226, v227
    v_pk_max_i16 v225, v225, 0
    v_mfma_f32_32x32x16_bf16 v[176:191], a[108:111], v[60:63], v[176:191]
    v_mul_f32_e64 v228, v228, |v228|
    v_mul_f32_e64 v229, v229, |v229|
    v_cvt_pk_bf16_f32 v226, v228, v229
    v_pk_max_i16 v226, v226, 0
    v_mul_f32_e64 v230, v230, |v230|
    v_mul_f32_e64 v231, v231, |v231|
    v_cvt_pk_bf16_f32 v227, v230, v231
    v_pk_max_i16 v227, v227, 0
    s_waitcnt lgkmcnt(12)
    v_mfma_f32_32x32x16_bf16 v[176:191], a[112:115], v[64:67], v[176:191]
    v_mul_f32_e64 v232, v232, |v232|
    v_mul_f32_e64 v233, v233, |v233|
    v_cvt_pk_bf16_f32 v228, v232, v233
    v_pk_max_i16 v228, v228, 0
    v_mul_f32_e64 v234, v234, |v234|
    v_mul_f32_e64 v235, v235, |v235|
    v_cvt_pk_bf16_f32 v229, v234, v235
    v_pk_max_i16 v229, v229, 0
    v_mfma_f32_32x32x16_bf16 v[176:191], a[116:119], v[68:71], v[176:191]
    v_mul_f32_e64 v236, v236, |v236|
    v_mul_f32_e64 v237, v237, |v237|
    v_cvt_pk_bf16_f32 v230, v236, v237
    v_pk_max_i16 v230, v230, 0
    v_mul_f32_e64 v238, v238, |v238|
    v_mul_f32_e64 v239, v239, |v239|
    v_cvt_pk_bf16_f32 v231, v238, v239
    v_pk_max_i16 v231, v231, 0
    s_waitcnt lgkmcnt(6)
    v_mfma_f32_32x32x16_bf16 v[176:191], a[120:123], v[72:75], v[176:191]
    ds_read_b64_tr_b16 a[252:253], v174 offset:26624
    ds_read_b64_tr_b16 a[254:255], v174 offset:27648
    s_add_u32 m0, s72, 2048
    s_nop 0
    buffer_load_dwordx4 v7, s[24:27], s94 offen lds
    v_mfma_f32_32x32x16_bf16 v[176:191], a[124:127], v[76:79], v[176:191]
    ds_read_b64_tr_b16 a[88:89], v174 offset:28672
    ds_read_b64_tr_b16 a[90:91], v174 offset:29696
    buffer_load_dwordx4 v15, s[24:27], s94 offen offset:1024 lds
    ds_read_b64_tr_b16 a[92:93], v174 offset:30720
    ds_read_b64_tr_b16 a[94:95], v174 offset:31744
    s_waitcnt lgkmcnt(8)
    v_mfma_f32_32x32x16_bf16 v[176:191], a[240:243], v[80:83], v[176:191]
    s_add_u32 m0, s72, 4096
    s_nop 0
    buffer_load_dwordx4 v7, s[24:27], s95 offen lds
    ds_read_b64_tr_b16 a[96:97], v174 offset:32768
    ds_read_b64_tr_b16 a[98:99], v174 offset:33792
    ds_read_b64_tr_b16 a[100:101], v174 offset:34816
    ds_read_b64_tr_b16 a[102:103], v174 offset:35840
    v_mfma_f32_32x32x16_bf16 v[176:191], a[244:247], v[84:87], v[176:191]
    buffer_load_dwordx4 v15, s[24:27], s95 offen offset:1024 lds
    ds_read_b64_tr_b16 a[104:105], v174 offset:36864
    ds_read_b64_tr_b16 a[106:107], v174 offset:37888
    ds_read_b64_tr_b16 a[108:109], v174 offset:38912
    ds_read_b64_tr_b16 a[110:111], v174 offset:39936
    s_waitcnt lgkmcnt(12)
    v_mfma_f32_32x32x16_bf16 v[176:191], a[248:251], v[88:91], v[176:191]
    s_add_u32 m0, s72, 6144
    s_nop 0
    buffer_load_dwordx4 v7, s[24:27], s96 offen lds
    ds_read_b64_tr_b16 a[112:113], v174 offset:40960
    ds_read_b64_tr_b16 a[114:115], v174 offset:41984
    ds_read_b64_tr_b16 a[116:117], v174 offset:43008
    ds_read_b64_tr_b16 a[118:119], v174 offset:44032
    v_mfma_f32_32x32x16_bf16 v[176:191], a[252:255], v[92:95], v[176:191]
    buffer_load_dwordx4 v15, s[24:27], s96 offen offset:1024 lds
    ds_read_b64_tr_b16 a[120:121], v174 offset:45056
    ds_read_b64_tr_b16 a[122:123], v174 offset:46080
    ds_read_b64_tr_b16 a[124:125], v174 offset:47104
    ds_read_b64_tr_b16 a[126:127], v174 offset:48128
    s_waitcnt lgkmcnt(15)
    v_mfma_f32_32x32x16_bf16 v[176:191], a[88:91], v[96:99], v[176:191]
    s_add_u32 s54, s87, 28672
    buffer_store_dwordx4 v[224:227], v2, s[32:35], s54 offen offset:0 nt
    buffer_store_dwordx4 v[228:231], v2, s[32:35], s54 offen offset:1024 nt
    v_mfma_f32_32x32x16_bf16 v[176:191], a[92:95], v[100:103], v[176:191]
    s_add_u32 m0, s72, 8192
    v_add_u32 v7, 28672, v7
    v_add_u32 v15, 6144, v7
    buffer_load_dwordx4 v7, s[24:27], s90 offen lds
    ds_read_b64_tr_b16 a[240:241], v174 offset:49152
    ds_read_b64_tr_b16 a[242:243], v174 offset:50176
    ds_read_b64_tr_b16 a[244:245], v174 offset:51200
    ds_read_b64_tr_b16 a[246:247], v174 offset:52224
    s_waitcnt lgkmcnt(15)
    v_mfma_f32_32x32x16_bf16 v[176:191], a[96:99], v[104:107], v[176:191]
    buffer_load_dwordx4 v15, s[24:27], s90 offen offset:1024 lds
    ds_read_b64_tr_b16 a[248:249], v174 offset:53248
    ds_read_b64_tr_b16 a[250:251], v174 offset:54272
    ds_read_b64_tr_b16 a[252:253], v174 offset:55296
    ds_read_b64_tr_b16 a[254:255], v174 offset:56320
    v_mfma_f32_32x32x16_bf16 v[176:191], a[100:103], v[108:111], v[176:191]
    s_add_u32 m0, s72, 10240
    s_nop 0
    buffer_load_dwordx4 v7, s[24:27], s91 offen lds
    ds_read_b64_tr_b16 a[88:89], v175 offset:0
    ds_read_b64_tr_b16 a[90:91], v175 offset:1024
    s_waitcnt lgkmcnt(15)
    v_mfma_f32_32x32x16_bf16 v[176:191], a[104:107], v[112:115], v[176:191]
    buffer_load_dwordx4 v15, s[24:27], s91 offen offset:1024 lds
    ds_read_b64_tr_b16 a[92:93], v175 offset:2048
    ds_read_b64_tr_b16 a[94:95], v175 offset:3072
    v_mfma_f32_32x32x16_bf16 v[176:191], a[108:111], v[116:119], v[176:191]
    s_add_u32 m0, s72, 12288
    s_nop 0
    buffer_load_dwordx4 v7, s[24:27], s92 offen lds
    ds_read_b64_tr_b16 a[96:97], v175 offset:4096
    ds_read_b64_tr_b16 a[98:99], v175 offset:5120
    s_waitcnt lgkmcnt(15)
    v_mfma_f32_32x32x16_bf16 v[176:191], a[112:115], v[120:123], v[176:191]
    buffer_load_dwordx4 v15, s[24:27], s92 offen offset:1024 lds
    s_waitcnt vmcnt(26)
    ds_read_b64_tr_b16 a[168:169], v8 offset:4096
    ds_read_b64_tr_b16 a[170:171], v8 offset:5120
    ds_read_b64_tr_b16 a[172:173], v9 offset:4096
    ds_read_b64_tr_b16 a[174:175], v9 offset:5120
    v_mfma_f32_32x32x16_bf16 v[176:191], a[116:119], v[124:127], v[176:191]
    ds_read_b64_tr_b16 a[100:101], v175 offset:6144
    ds_read_b64_tr_b16 a[102:103], v175 offset:7168
    ds_read_b64_tr_b16 a[104:105], v175 offset:8192
    ds_read_b64_tr_b16 a[106:107], v175 offset:9216
    s_waitcnt lgkmcnt(15)
    v_mfma_f32_32x32x16_bf16 v[176:191], a[120:123], v[128:131], v[176:191]
    s_waitcnt vmcnt(24)
    ds_read_b64_tr_b16 a[176:177], v8 offset:6144
    ds_read_b64_tr_b16 a[178:179], v8 offset:7168
    ds_read_b64_tr_b16 a[180:181], v9 offset:6144
    ds_read_b64_tr_b16 a[182:183], v9 offset:7168
    v_mfma_f32_32x32x16_bf16 v[176:191], a[124:127], v[132:135], v[176:191]
    s_waitcnt lgkmcnt(8)
    s_add_u32 m0, s83, 4096
    s_nop 0
    buffer_load_dwordx4 v7, s[24:27], s93 offen lds
    ds_read_b64_tr_b16 a[108:109], v175 offset:10240
    ds_read_b64_tr_b16 a[110:111], v175 offset:11264
    ds_read_b64_tr_b16 a[112:113], v175 offset:12288
    ds_read_b64_tr_b16 a[114:115], v175 offset:13312
    v_mfma_f32_32x32x16_bf16 v[176:191], a[240:243], v[136:139], v[176:191]
    buffer_load_dwordx4 v15, s[24:27], s93 offen offset:1024 lds
    s_waitcnt vmcnt(24)
    ds_read_b64_tr_b16 a[184:185], v8 offset:8192
    ds_read_b64_tr_b16 a[186:187], v8 offset:9216
    ds_read_b64_tr_b16 a[188:189], v9 offset:8192
    ds_read_b64_tr_b16 a[190:191], v9 offset:9216
    v_mfma_f32_32x32x16_bf16 v[176:191], a[244:247], v[140:143], v[176:191]
    ds_read_b64_tr_b16 a[116:117], v175 offset:14336
    ds_read_b64_tr_b16 a[118:119], v175 offset:15360
    ds_read_b64_tr_b16 a[120:121], v175 offset:16384
    ds_read_b64_tr_b16 a[122:123], v175 offset:17408
    v_mfma_f32_32x32x16_bf16 v[176:191], a[248:251], v[144:147], v[176:191]
    s_waitcnt vmcnt(8)
    s_mov_b64 exec, 1
    buffer_store_dword v3, off, s[32:35], s88
    s_mov_b64 exec, -1
    v_mfma_f32_32x32x16_bf16 v[176:191], a[252:255], v[148:151], v[176:191]
    v_mfma_f32_32x32x16_bf16 v[176:191], v[160:163], v[168:171], v[176:191]
    ds_read_b64_tr_b16 a[192:193], v8 offset:0
    ds_read_b64_tr_b16 a[194:195], v8 offset:1024
    ds_read_b64_tr_b16 a[196:197], v9 offset:0
    ds_read_b64_tr_b16 a[198:199], v9 offset:1024
    v_mfma_f32_32x32x16_bf16 v[192:207], a[88:91], v[40:43], 0
    s_waitcnt lgkmcnt(15)
    s_add_u32 m0, s83, 6144
    s_nop 0
    buffer_load_dwordx4 v7, s[24:27], s94 offen lds
    ds_read_b64_tr_b16 a[200:201], v8 offset:2048
    ds_read_b64_tr_b16 a[202:203], v8 offset:3072
    v_mfma_f32_32x32x16_bf16 v[192:207], a[92:95], v[44:47], v[192:207]
    buffer_load_dwordx4 v15, s[24:27], s94 offen offset:1024 lds
    ds_read_b64_tr_b16 a[204:205], v9 offset:2048
    ds_read_b64_tr_b16 a[206:207], v9 offset:3072
    ds_read_b64_tr_b16 a[124:125], v175 offset:18432
    ds_read_b64_tr_b16 a[126:127], v175 offset:19456
    v_mfma_f32_32x32x16_bf16 v[192:207], a[96:99], v[48:51], v[192:207]
    v_mul_f32_e64 v176, v176, |v176|
    v_mul_f32_e64 v177, v177, |v177|
    v_cvt_pk_bf16_f32 v176, v176, v177
    v_pk_max_i16 v176, v176, 0
    v_mul_f32_e64 v178, v178, |v178|
    v_mul_f32_e64 v179, v179, |v179|
    v_cvt_pk_bf16_f32 v177, v178, v179
    v_pk_max_i16 v177, v177, 0
    v_mfma_f32_32x32x16_bf16 v[192:207], a[100:103], v[52:55], v[192:207]
    v_mul_f32_e64 v180, v180, |v180|
    v_mul_f32_e64 v181, v181, |v181|
    v_cvt_pk_bf16_f32 v178, v180, v181
    v_pk_max_i16 v178, v178, 0
    v_mul_f32_e64 v182, v182, |v182|
    v_mul_f32_e64 v183, v183, |v183|
    v_cvt_pk_bf16_f32 v179, v182, v183
    v_pk_max_i16 v179, v179, 0
    s_waitcnt lgkmcnt(15)
    v_mfma_f32_32x32x16_bf16 v[192:207], a[104:107], v[56:59], v[192:207]
    s_nop 0
    v_mul_f32_e64 v184, v184, |v184|
    v_mul_f32_e64 v185, v185, |v185|
    v_cvt_pk_bf16_f32 v180, v184, v185
    v_pk_max_i16 v180, v180, 0
    v_mul_f32_e64 v186, v186, |v186|
    v_mul_f32_e64 v187, v187, |v187|
    v_cvt_pk_bf16_f32 v181, v186, v187
    v_mfma_f32_32x32x16_bf16 v[192:207], a[108:111], v[60:63], v[192:207]
    ds_read_b64_tr_b16 a[240:241], v175 offset:20480
    ds_read_b64_tr_b16 a[242:243], v175 offset:21504
    v_pk_max_i16 v181, v181, 0
    v_mul_f32_e64 v188, v188, |v188|
    v_mul_f32_e64 v189, v189, |v189|
    v_cvt_pk_bf16_f32 v182, v188, v189
    v_pk_max_i16 v182, v182, 0
    v_mul_f32_e64 v190, v190, |v190|
    s_waitcnt lgkmcnt(14)
    v_mfma_f32_32x32x16_bf16 v[192:207], a[112:115], v[64:67], v[192:207]
    ds_read_b64_tr_b16 a[244:245], v175 offset:22528
    ds_read_b64_tr_b16 a[246:247], v175 offset:23552
    buffer_load_dword v12, v10, s[32:35], s89 offen sc1
    v_add_u32 v37, s76, v2
    v_add_u32 v38, s77, v2
    v_mfma_f32_32x32x16_bf16 v[192:207], a[116:119], v[68:71], v[192:207]
    ds_read_b64_tr_b16 a[248:249], v175 offset:24576
    ds_read_b64_tr_b16 a[250:251], v175 offset:25600
    v_mul_f32_e64 v191, v191, |v191|
    v_cvt_pk_bf16_f32 v183, v190, v191
    v_pk_max_i16 v183, v183, 0
    s_waitcnt lgkmcnt(6)
    v_mfma_f32_32x32x16_bf16 v[192:207], a[120:123], v[72:75], v[192:207]
    ds_read_b64_tr_b16 a[252:253], v175 offset:26624
    ds_read_b64_tr_b16 a[254:255], v175 offset:27648
    ds_read_b64_tr_b16 a[208:209], v5 offset:0
    ds_read_b64_tr_b16 a[210:211], v5 offset:1024
    v_mfma_f32_32x32x16_bf16 v[192:207], a[124:127], v[76:79], v[192:207]
    ds_read_b64_tr_b16 a[88:89], v175 offset:28672
    ds_read_b64_tr_b16 a[90:91], v175 offset:29696
    s_add_u32 m0, s83, 8192
    s_nop 0
    buffer_load_dwordx4 v7, s[24:27], s95 offen lds
    s_waitcnt lgkmcnt(8)
    v_mfma_f32_32x32x16_bf16 v[192:207], a[240:243], v[80:83], v[192:207]
    ds_read_b64_tr_b16 a[92:93], v175 offset:30720
    ds_read_b64_tr_b16 a[94:95], v175 offset:31744
    s_add_u32 s54, s87, 57344
    buffer_store_dwordx4 v[176:179], v2, s[32:35], s54 offen offset:0 nt
    buffer_store_dwordx4 v[180:183], v2, s[32:35], s54 offen offset:1024 nt
    v_mfma_f32_32x32x16_bf16 v[192:207], a[244:247], v[84:87], v[192:207]
    ds_read_b64_tr_b16 a[96:97], v175 offset:32768
    ds_read_b64_tr_b16 a[98:99], v175 offset:33792
    buffer_load_dwordx4 v15, s[24:27], s95 offen offset:1024 lds
    ds_read_b64_tr_b16 a[212:213], v14 offset:0
    ds_read_b64_tr_b16 a[214:215], v14 offset:1024
    s_waitcnt lgkmcnt(10)
    v_mfma_f32_32x32x16_bf16 v[192:207], a[248:251], v[88:91], v[192:207]
    ds_read_b64_tr_b16 a[100:101], v175 offset:34816
    ds_read_b64_tr_b16 a[102:103], v175 offset:35840
    ds_read_b64_tr_b16 a[216:217], v5 offset:2048
    ds_read_b64_tr_b16 a[218:219], v5 offset:3072
    v_mfma_f32_32x32x16_bf16 v[192:207], a[252:255], v[92:95], v[192:207]
    ds_read_b64_tr_b16 a[104:105], v175 offset:36864
    ds_read_b64_tr_b16 a[106:107], v175 offset:37888
    ds_read_b64_tr_b16 a[220:221], v14 offset:2048
    ds_read_b64_tr_b16 a[222:223], v14 offset:3072
    ds_read_b64_tr_b16 a[108:109], v175 offset:38912
    ds_read_b64_tr_b16 a[110:111], v175 offset:39936
    s_waitcnt lgkmcnt(14)
    v_mfma_f32_32x32x16_bf16 v[192:207], a[88:91], v[96:99], v[192:207]
    s_add_u32 m0, s83, 0
    s_nop 0
    buffer_load_dwordx4 v7, s[24:27], s96 offen lds
    ds_read_b64_tr_b16 a[224:225], v5 offset:4096
    ds_read_b64_tr_b16 a[226:227], v5 offset:5120
    v_mfma_f32_32x32x16_bf16 v[192:207], a[92:95], v[100:103], v[192:207]
    ds_read_b64_tr_b16 a[112:113], v175 offset:40960
    ds_read_b64_tr_b16 a[114:115], v175 offset:41984
    buffer_load_dwordx4 v15, s[24:27], s96 offen offset:1024 lds
    ds_read_b64_tr_b16 a[228:229], v14 offset:4096
    ds_read_b64_tr_b16 a[230:231], v14 offset:5120
    s_waitcnt lgkmcnt(14)
    v_mfma_f32_32x32x16_bf16 v[192:207], a[96:99], v[104:107], v[192:207]
    ds_read_b64_tr_b16 a[116:117], v175 offset:43008
    ds_read_b64_tr_b16 a[118:119], v175 offset:44032
    s_waitcnt vmcnt(6)
    v_cmp_ne_u32 vcc, s7, v12
    s_cbranch_vccz Ldone_12
    s_mov_b32 s56, 0x100000
Lpoll_11:
    buffer_load_dword v12, v10, s[32:35], s89 offen sc1
    s_waitcnt vmcnt(0)
    v_cmp_ne_u32 vcc, s7, v12
    s_cbranch_vccz Ldone_12
    s_sub_u32 s56, s56, 1
    s_cbranch_scc0 Lpoll_11
Ldone_12:
    buffer_load_dwordx4 a[32:35], v38, s[32:35], s36 offen sc1
    buffer_load_dwordx4 a[36:39], v38, s[32:35], s37 offen sc1
    v_mfma_f32_32x32x16_bf16 v[192:207], a[100:103], v[108:111], v[192:207]
    ds_read_b64_tr_b16 a[120:121], v175 offset:45056
    ds_read_b64_tr_b16 a[122:123], v175 offset:46080
    buffer_load_dwordx4 a[40:43], v38, s[32:35], s38 offen sc1
    ds_read_b64_tr_b16 a[124:125], v175 offset:47104
    ds_read_b64_tr_b16 a[126:127], v175 offset:48128
    s_waitcnt lgkmcnt(12)
    v_mfma_f32_32x32x16_bf16 v[192:207], a[104:107], v[112:115], v[192:207]
    buffer_load_dwordx4 a[44:47], v38, s[32:35], s39 offen sc1
    buffer_load_dwordx4 a[48:51], v38, s[32:35], s40 offen sc1
    v_mfma_f32_32x32x16_bf16 v[192:207], a[108:111], v[116:119], v[192:207]
    ds_read_b64_tr_b16 a[240:241], v175 offset:49152
    ds_read_b64_tr_b16 a[242:243], v175 offset:50176
    buffer_load_dwordx4 a[52:55], v38, s[32:35], s41 offen sc1
    ds_read_b64_tr_b16 a[244:245], v175 offset:51200
    ds_read_b64_tr_b16 a[246:247], v175 offset:52224
    s_waitcnt lgkmcnt(8)
    v_mfma_f32_32x32x16_bf16 v[192:207], a[112:115], v[120:123], v[192:207]
    s_add_u32 s53, s53, 4096
    buffer_load_dword v36, v30, s[32:35], s53 offen sc1
    buffer_load_dwordx4 a[56:59], v38, s[32:35], s42 offen sc1
    v_mfma_f32_32x32x16_bf16 v[192:207], a[116:119], v[124:127], v[192:207]
    ds_read_b64_tr_b16 a[248:249], v175 offset:53248
    ds_read_b64_tr_b16 a[250:251], v175 offset:54272
    buffer_load_dwordx4 a[60:63], v37, s[32:35], s36 offen sc1
    ds_read_b64_tr_b16 a[252:253], v175 offset:55296
    ds_read_b64_tr_b16 a[254:255], v175 offset:56320
    s_waitcnt lgkmcnt(8)
    v_mfma_f32_32x32x16_bf16 v[192:207], a[120:123], v[128:131], v[192:207]
    buffer_load_dwordx4 a[64:67], v37, s[32:35], s37 offen sc1
    buffer_load_dwordx4 a[68:71], v37, s[32:35], s38 offen sc1
    v_mfma_f32_32x32x16_bf16 v[192:207], a[124:127], v[132:135], v[192:207]
    buffer_load_dwordx4 a[72:75], v37, s[32:35], s39 offen sc1
    s_waitcnt lgkmcnt(4)
    v_mfma_f32_32x32x16_bf16 v[192:207], a[240:243], v[136:139], v[192:207]
    buffer_load_dwordx4 a[76:79], v37, s[32:35], s40 offen sc1
    ds_read_b64_tr_b16 a[232:233], v5 offset:6144
    ds_read_b64_tr_b16 a[234:235], v5 offset:7168
    v_mfma_f32_32x32x16_bf16 v[192:207], a[244:247], v[140:143], v[192:207]
    buffer_load_dwordx4 a[80:83], v37, s[32:35], s41 offen sc1
    s_add_u32 m0, s83, 2048
    v_add_u32 v7, 28672, v7
    v_add_u32 v15, 6144, v7
    buffer_load_dwordx4 v7, s[24:27], s90 offen lds
    s_waitcnt lgkmcnt(2)
    v_mfma_f32_32x32x16_bf16 v[192:207], a[248:251], v[144:147], v[192:207]
    buffer_load_dwordx4 a[84:87], v37, s[32:35], s42 offen sc1
    buffer_load_dwordx4 v15, s[24:27], s90 offen offset:1024 lds
    v_mfma_f32_32x32x16_bf16 v[192:207], a[252:255], v[148:151], v[192:207]
    v_mfma_f32_32x32x16_bf16 v[192:207], v[164:167], v[168:171], v[192:207]
    ds_read_b64_tr_b16 a[236:237], v14 offset:6144
    ds_read_b64_tr_b16 a[238:239], v14 offset:7168
    v_mov_b32 v39, v30
    s_waitcnt vmcnt(16)
    v_mfma_f32_32x32x16_bf16 v[208:223], a[128:131], a[32:35], 0
    v_add_u32 v25, 28672, v37
    v_add_u32 v26, 57344, v37
    v_add_u32 v27, 86016, v37
    v_add_u32 v29, 28672, v38
    v_mfma_f32_32x32x16_bf16 v[224:239], a[132:135], a[32:35], 0
    v_add_u32 v30, 57344, v38
    v_add_u32 v31, 86016, v38
    s_add_u32 m0, s72, 0
    s_nop 0
    buffer_load_dwordx4 v7, s[24:27], s91 offen lds
    buffer_load_dwordx4 v15, s[24:27], s91 offen offset:1024 lds
    s_waitcnt vmcnt(17)
    v_mfma_f32_32x32x16_bf16 v[208:223], a[136:139], a[36:39], v[208:223]
    v_mul_f32_e64 v192, v192, |v192|
    v_mul_f32_e64 v193, v193, |v193|
    v_cvt_pk_bf16_f32 v192, v192, v193
    v_pk_max_i16 v192, v192, 0
    v_mul_f32_e64 v194, v194, |v194|
    v_mul_f32_e64 v195, v195, |v195|
    v_cvt_pk_bf16_f32 v193, v194, v195
    v_mfma_f32_32x32x16_bf16 v[224:239], a[140:143], a[36:39], v[224:239]
    v_pk_max_i16 v193, v193, 0
    v_mul_f32_e64 v196, v196, |v196|
    v_mul_f32_e64 v197, v197, |v197|
    v_cvt_pk_bf16_f32 v194, v196, v197
    v_pk_max_i16 v194, v194, 0
    s_waitcnt vmcnt(16)
    v_mfma_f32_32x32x16_bf16 v[208:223], a[144:147], a[40:43], v[208:223]
    v_mul_f32_e64 v198, v198, |v198|
    v_mul_f32_e64 v199, v199, |v199|
    v_cvt_pk_bf16_f32 v195, v198, v199
    v_pk_max_i16 v195, v195, 0
    v_mul_f32_e64 v200, v200, |v200|
    v_mul_f32_e64 v201, v201, |v201|
    v_cvt_pk_bf16_f32 v196, v200, v201
    v_mfma_f32_32x32x16_bf16 v[224:239], a[148:151], a[40:43], v[224:239]
    v_pk_max_i16 v196, v196, 0
    v_mul_f32_e64 v202, v202, |v202|
    v_mul_f32_e64 v203, v203, |v203|
    v_cvt_pk_bf16_f32 v197, v202, v203
    s_add_u32 m0, s72, 2048
    s_nop 0
    buffer_load_dwordx4 v7, s[24:27], s92 offen lds
    buffer_load_dwordx4 v15, s[24:27], s92 offen offset:1024 lds
    s_waitcnt vmcnt(17)
    v_mfma_f32_32x32x16_bf16 v[208:223], a[152:155], a[44:47], v[208:223]
    v_pk_max_i16 v197, v197, 0
    v_mul_f32_e64 v204, v204, |v204|
    v_mul_f32_e64 v205, v205, |v205|
    v_cvt_pk_bf16_f32 v198, v204, v205
    v_pk_max_i16 v198, v198, 0
    v_mul_f32_e64 v206, v206, |v206|
    v_mfma_f32_32x32x16_bf16 v[224:239], a[156:159], a[44:47], v[224:239]
    v_mul_f32_e64 v207, v207, |v207|
    v_cvt_pk_bf16_f32 v199, v206, v207
    v_pk_max_i16 v199, v199, 0
    s_waitcnt vmcnt(14)
    v_cmp_ne_u32 vcc, s7, v36
    s_cbranch_vccz Ldone_14
    s_mov_b32 s56, 0x100000
Lpoll_13:
    buffer_load_dword v36, v39, s[32:35], s53 offen sc1
    s_waitcnt vmcnt(0)
    v_cmp_ne_u32 vcc, s7, v36
    s_cbranch_vccz Ldone_14
    s_sub_u32 s56, s56, 1
    s_cbranch_scc0 Lpoll_13
Ldone_14:
    s_add_u32 s54, s87, 86016
    buffer_store_dwordx4 v[192:195], v2, s[32:35], s54 offen offset:0 nt
    buffer_store_dwordx4 v[196:199], v2, s[32:35], s54 offen offset:1024 nt
    s_add_u32 m0, s72, 4096
    s_nop 0
    buffer_load_dwordx4 v7, s[24:27], s93 offen lds
    v_mfma_f32_32x32x16_bf16 v[208:223], a[160:163], a[48:51], v[208:223]
    buffer_load_dwordx4 v15, s[24:27], s93 offen offset:1024 lds
    v_mfma_f32_32x32x16_bf16 v[224:239], a[164:167], a[48:51], v[224:239]
    v_mfma_f32_32x32x16_bf16 v[208:223], a[168:171], a[52:55], v[208:223]
    s_waitcnt lgkmcnt(0)
    s_add_u32 m0, s72, 6144
    s_nop 0
    buffer_load_dwordx4 v7, s[24:27], s94 offen lds
    v_mfma_f32_32x32x16_bf16 v[224:239], a[172:175], a[52:55], v[224:239]
    buffer_load_dwordx4 v15, s[24:27], s94 offen offset:1024 lds
    s_waitcnt vmcnt(19)
    v_mfma_f32_32x32x16_bf16 v[208:223], a[176:179], a[56:59], v[208:223]
    v_mfma_f32_32x32x16_bf16 v[224:239], a[180:183], a[56:59], v[224:239]
    s_waitcnt vmcnt(18)
    v_mfma_f32_32x32x16_bf16 v[176:191], a[128:131], a[60:63], 0
    v_mfma_f32_32x32x16_bf16 v[192:207], a[132:135], a[60:63], 0
    s_waitcnt vmcnt(17)
    v_mfma_f32_32x32x16_bf16 v[176:191], a[136:139], a[64:67], v[176:191]
    buffer_load_dwordx4 v[80:83], v29, s[32:35], s36 offen sc1
    v_mfma_f32_32x32x16_bf16 v[192:207], a[140:143], a[64:67], v[192:207]
    s_add_u32 s88, s88, 4096
    s_waitcnt vmcnt(5)
    s_mov_b64 exec, 1
    buffer_store_dword v3, off, s[32:35], s88
    s_mov_b64 exec, -1
    v_mfma_f32_32x32x16_bf16 v[176:191], a[144:147], a[68:71], v[176:191]
    buffer_load_dwordx4 v[84:87], v29, s[32:35], s37 offen sc1
    v_mfma_f32_32x32x16_bf16 v[192:207], a[148:151], a[68:71], v[192:207]
    v_mfma_f32_32x32x16_bf16 v[176:191], a[152:155], a[72:75], v[176:191]
    buffer_load_dwordx4 v[88:91], v29, s[32:35], s38 offen sc1
    v_mfma_f32_32x32x16_bf16 v[192:207], a[156:159], a[72:75], v[192:207]
    v_mfma_f32_32x32x16_bf16 v[176:191], a[160:163], a[76:79], v[176:191]
    buffer_load_dwordx4 v[92:95], v29, s[32:35], s39 offen sc1
    v_mfma_f32_32x32x16_bf16 v[192:207], a[164:167], a[76:79], v[192:207]
    v_mfma_f32_32x32x16_bf16 v[176:191], a[168:171], a[80:83], v[176:191]
    buffer_load_dwordx4 v[96:99], v29, s[32:35], s40 offen sc1
    v_mfma_f32_32x32x16_bf16 v[192:207], a[172:175], a[80:83], v[192:207]
    v_mfma_f32_32x32x16_bf16 v[176:191], a[176:179], a[84:87], v[176:191]
    buffer_load_dwordx4 v[100:103], v29, s[32:35], s41 offen sc1
    v_mfma_f32_32x32x16_bf16 v[192:207], a[180:183], a[84:87], v[192:207]
    s_waitcnt vmcnt(6)
    v_mfma_f32_32x32x16_bf16 v[208:223], a[184:187], v[80:83], v[208:223]
    buffer_load_dwordx4 v[104:107], v29, s[32:35], s42 offen sc1
    v_mfma_f32_32x32x16_bf16 v[224:239], a[188:191], v[80:83], v[224:239]
    s_waitcnt vmcnt(5)
    v_mfma_f32_32x32x16_bf16 v[208:223], a[192:195], v[84:87], v[208:223]
    buffer_load_dwordx4 v[108:111], v25, s[32:35], s36 offen sc1
    v_mfma_f32_32x32x16_bf16 v[224:239], a[196:199], v[84:87], v[224:239]
    ds_read_b64_tr_b16 a[0:1], v5 offset:8192
    ds_read_b64_tr_b16 a[2:3], v5 offset:9216
    ds_read_b64_tr_b16 a[4:5], v14 offset:8192
    ds_read_b64_tr_b16 a[6:7], v14 offset:9216
    s_waitcnt lgkmcnt(0)
    s_add_u32 m0, s72, 8192
    s_nop 0
    buffer_load_dwordx4 v7, s[24:27], s95 offen lds
    s_waitcnt vmcnt(6)
    v_mfma_f32_32x32x16_bf16 v[208:223], a[200:203], v[88:91], v[208:223]
    buffer_load_dwordx4 v[112:115], v25, s[32:35], s37 offen sc1
    s_add_u32 s89, s89, 4096
    buffer_load_dword v12, v10, s[32:35], s89 offen sc1
    v_mfma_f32_32x32x16_bf16 v[224:239], a[204:207], v[88:91], v[224:239]
    buffer_load_dwordx4 v15, s[24:27], s95 offen offset:1024 lds
    s_waitcnt vmcnt(8)
    v_mfma_f32_32x32x16_bf16 v[208:223], a[208:211], v[92:95], v[208:223]
    buffer_load_dwordx4 v[116:119], v25, s[32:35], s38 offen sc1
    v_mfma_f32_32x32x16_bf16 v[224:239], a[212:215], v[92:95], v[224:239]
    ds_read_b64_tr_b16 a[8:9], v5 offset:10240
    ds_read_b64_tr_b16 a[10:11], v5 offset:11264
    ds_read_b64_tr_b16 a[12:13], v14 offset:10240
    ds_read_b64_tr_b16 a[14:15], v14 offset:11264
    s_waitcnt lgkmcnt(0)
    s_add_u32 m0, s72, 10240
    s_nop 0
    buffer_load_dwordx4 v7, s[24:27], s96 offen lds
    s_waitcnt vmcnt(9)
    v_mfma_f32_32x32x16_bf16 v[208:223], a[216:219], v[96:99], v[208:223]
    buffer_load_dwordx4 v[72:75], v25, s[32:35], s39 offen sc1
    v_mfma_f32_32x32x16_bf16 v[224:239], a[220:223], v[96:99], v[224:239]
    buffer_load_dwordx4 v15, s[24:27], s96 offen offset:1024 lds
    s_waitcnt vmcnt(10)
    v_mfma_f32_32x32x16_bf16 v[208:223], a[224:227], v[100:103], v[208:223]
    buffer_load_dwordx4 v[76:79], v25, s[32:35], s40 offen sc1
    v_mfma_f32_32x32x16_bf16 v[224:239], a[228:231], v[100:103], v[224:239]
    s_waitcnt vmcnt(10)
    v_mfma_f32_32x32x16_bf16 v[208:223], a[232:235], v[104:107], v[208:223]
    buffer_load_dwordx4 v[80:83], v25, s[32:35], s41 offen sc1
    v_mfma_f32_32x32x16_bf16 v[224:239], a[236:239], v[104:107], v[224:239]
    s_barrier
    ds_read_b32 v168, v13
    s_waitcnt vmcnt(10)
    v_mfma_f32_32x32x16_bf16 v[176:191], a[184:187], v[108:111], v[176:191]
    buffer_load_dwordx4 v[84:87], v25, s[32:35], s42 offen sc1
    v_mfma_f32_32x32x16_bf16 v[192:207], a[188:191], v[108:111], v[192:207]
    s_waitcnt vmcnt(9)
    v_mfma_f32_32x32x16_bf16 v[176:191], a[192:195], v[112:115], v[176:191]
    s_waitcnt vmcnt(8)
    v_cmp_ne_u32 vcc, s7, v12
    s_cbranch_vccz Ldone_16
    s_mov_b32 s56, 0x100000
Lpoll_15:
    buffer_load_dword v12, v10, s[32:35], s89 offen sc1
    s_waitcnt vmcnt(0)
    v_cmp_ne_u32 vcc, s7, v12
    s_cbranch_vccz Ldone_16
    s_sub_u32 s56, s56, 1
    s_cbranch_scc0 Lpoll_15
Ldone_16:
    buffer_load_dwordx4 v[88:91], v30, s[32:35], s36 offen sc1
    v_mfma_f32_32x32x16_bf16 v[192:207], a[196:199], v[112:115], v[192:207]
    s_waitcnt vmcnt(7)
    v_mfma_f32_32x32x16_bf16 v[176:191], a[200:203], v[116:119], v[176:191]
    buffer_load_dwordx4 v[92:95], v30, s[32:35], s37 offen sc1
    ds_read_b64_tr_b16 a[16:17], v5 offset:12288
    ds_read_b64_tr_b16 a[18:19], v5 offset:13312
    v_mfma_f32_32x32x16_bf16 v[192:207], a[204:207], v[116:119], v[192:207]
    ds_read_b64_tr_b16 a[20:21], v14 offset:12288
    ds_read_b64_tr_b16 a[22:23], v14 offset:13312
    s_waitcnt vmcnt(6)
    v_mfma_f32_32x32x16_bf16 v[176:191], a[208:211], v[72:75], v[176:191]
    buffer_load_dwordx4 v[96:99], v30, s[32:35], s38 offen sc1
    ds_read_b64_tr_b16 a[24:25], v8 offset:4096
    ds_read_b64_tr_b16 a[26:27], v8 offset:5120
    v_mfma_f32_32x32x16_bf16 v[192:207], a[212:215], v[72:75], v[192:207]
    ds_read_b64_tr_b16 a[28:29], v9 offset:4096
    ds_read_b64_tr_b16 a[30:31], v9 offset:5120
    s_waitcnt vmcnt(5)
    v_mfma_f32_32x32x16_bf16 v[176:191], a[216:219], v[76:79], v[176:191]
    buffer_load_dwordx4 v[100:103], v30, s[32:35], s39 offen sc1
    ds_read_b64_tr_b16 a[32:33], v8 offset:6144
    ds_read_b64_tr_b16 a[34:35], v8 offset:7168
    v_mfma_f32_32x32x16_bf16 v[192:207], a[220:223], v[76:79], v[192:207]
    ds_read_b64_tr_b16 a[36:37], v9 offset:6144
    ds_read_b64_tr_b16 a[38:39], v9 offset:7168
    s_waitcnt vmcnt(5)
    v_mfma_f32_32x32x16_bf16 v[176:191], a[224:227], v[80:83], v[176:191]
    buffer_load_dwordx4 v[104:107], v30, s[32:35], s40 offen sc1
    ds_read_b64_tr_b16 a[40:41], v8 offset:8192
    ds_read_b64_tr_b16 a[42:43], v8 offset:9216
    v_mfma_f32_32x32x16_bf16 v[192:207], a[228:231], v[80:83], v[192:207]
    ds_read_b64_tr_b16 a[44:45], v9 offset:8192
    ds_read_b64_tr_b16 a[46:47], v9 offset:9216
    s_waitcnt vmcnt(5)
    v_mfma_f32_32x32x16_bf16 v[176:191], a[232:235], v[84:87], v[176:191]
    buffer_load_dwordx4 v[108:111], v30, s[32:35], s41 offen sc1
    ds_read_b64_tr_b16 a[48:49], v8 offset:0
    ds_read_b64_tr_b16 a[50:51], v8 offset:1024
    v_mfma_f32_32x32x16_bf16 v[192:207], a[236:239], v[84:87], v[192:207]
    ds_read_b64_tr_b16 a[52:53], v9 offset:0
    ds_read_b64_tr_b16 a[54:55], v9 offset:1024
    s_waitcnt vmcnt(5)
    v_mfma_f32_32x32x16_bf16 v[208:223], a[0:3], v[88:91], v[208:223]
    buffer_load_dwordx4 v[112:115], v30, s[32:35], s42 offen sc1
    ds_read_b64_tr_b16 a[56:57], v8 offset:2048
    ds_read_b64_tr_b16 a[58:59], v8 offset:3072
    ds_read_b64_tr_b16 a[60:61], v9 offset:2048
    ds_read_b64_tr_b16 a[62:63], v9 offset:3072
    v_lshlrev_b32 v170, 16, v240
    v_mfma_f32_32x32x16_bf16 v[224:239], a[4:7], v[88:91], v[224:239]
    v_and_b32 v171, 0xffff0000, v240
    v_lshlrev_b32 v172, 16, v248
    v_and_b32 v173, 0xffff0000, v248
    v_add_f32 v152, v170, v172
    s_waitcnt vmcnt(5)
    v_mfma_f32_32x32x16_bf16 v[208:223], a[8:11], v[92:95], v[208:223]
    buffer_load_dwordx4 v[116:119], v31, s[32:35], s36 offen sc1
    ds_read_b64_tr_b16 a[64:65], v5 offset:0
    ds_read_b64_tr_b16 a[66:67], v5 offset:1024
    ds_read_b64_tr_b16 a[68:69], v14 offset:0
    ds_read_b64_tr_b16 a[70:71], v14 offset:1024
    v_add_f32 v153, v171, v173
    v_mfma_f32_32x32x16_bf16 v[224:239], a[12:15], v[92:95], v[224:239]
    v_lshlrev_b32 v170, 16, v241
    v_and_b32 v171, 0xffff0000, v241
    v_lshlrev_b32 v172, 16, v249
    v_and_b32 v173, 0xffff0000, v249
    s_waitcnt vmcnt(5) lgkmcnt(15)
    v_mfma_f32_32x32x16_bf16 v[208:223], a[16:19], v[96:99], v[208:223]
    buffer_load_dwordx4 v[72:75], v31, s[32:35], s37 offen sc1
    ds_read_b64_tr_b16 a[72:73], v5 offset:2048
    ds_read_b64_tr_b16 a[74:75], v5 offset:3072
    ds_read_b64_tr_b16 a[76:77], v14 offset:2048
    ds_read_b64_tr_b16 a[78:79], v14 offset:3072
    v_add_f32 v154, v170, v172
    v_mfma_f32_32x32x16_bf16 v[224:239], a[20:23], v[96:99], v[224:239]
    v_add_f32 v155, v171, v173
    v_lshlrev_b32 v170, 16, v242
    v_and_b32 v171, 0xffff0000, v242
    v_lshlrev_b32 v172, 16, v250
    s_waitcnt vmcnt(5)
    v_mfma_f32_32x32x16_bf16 v[208:223], a[24:27], v[100:103], v[208:223]
    buffer_load_dwordx4 v[76:79], v31, s[32:35], s38 offen sc1
    ds_read_b64_tr_b16 a[80:81], v5 offset:4096
    ds_read_b64_tr_b16 a[82:83], v5 offset:5120
    ds_read_b64_tr_b16 a[84:85], v14 offset:4096
    ds_read_b64_tr_b16 a[86:87], v14 offset:5120
    v_and_b32 v173, 0xffff0000, v250
    v_mfma_f32_32x32x16_bf16 v[224:239], a[28:31], v[100:103], v[224:239]
    v_add_f32 v156, v170, v172
    v_add_f32 v157, v171, v173
    v_lshlrev_b32 v170, 16, v243
    v_and_b32 v171, 0xffff0000, v243
    s_waitcnt vmcnt(5)
    v_mfma_f32_32x32x16_bf16 v[208:223], a[32:35], v[104:107], v[208:223]
    buffer_load_dwordx4 v[80:83], v31, s[32:35], s39 offen sc1
    ds_read_b64_tr_b16 a[88:89], v5 offset:6144
    ds_read_b64_tr_b16 a[90:91], v5 offset:7168
    ds_read_b64_tr_b16 a[92:93], v14 offset:6144
    ds_read_b64_tr_b16 a[94:95], v14 offset:7168
    v_lshlrev_b32 v172, 16, v251
    v_mfma_f32_32x32x16_bf16 v[224:239], a[36:39], v[104:107], v[224:239]
    v_and_b32 v173, 0xffff0000, v251
    v_add_f32 v158, v170, v172
    v_add_f32 v159, v171, v173
    v_lshlrev_b32 v170, 16, v244
    s_waitcnt vmcnt(5) lgkmcnt(15)
    v_mfma_f32_32x32x16_bf16 v[208:223], a[40:43], v[108:111], v[208:223]
    buffer_load_dwordx4 v[84:87], v31, s[32:35], s40 offen sc1
    ds_read_b64_tr_b16 a[96:97], v5 offset:8192
    ds_read_b64_tr_b16 a[98:99], v5 offset:9216
    ds_read_b64_tr_b16 a[100:101], v14 offset:8192
    ds_read_b64_tr_b16 a[102:103], v14 offset:9216
    v_and_b32 v171, 0xffff0000, v244
    v_mfma_f32_32x32x16_bf16 v[224:239], a[44:47], v[108:111], v[224:239]
    v_lshlrev_b32 v172, 16, v252
    v_and_b32 v173, 0xffff0000, v252
    v_add_f32 v160, v170, v172
    v_add_f32 v161, v171, v173
    s_waitcnt vmcnt(5)
    v_mfma_f32_32x32x16_bf16 v[208:223], a[48:51], v[112:115], v[208:223]
    buffer_load_dwordx4 v[88:91], v31, s[32:35], s41 offen sc1
    ds_read_b64_tr_b16 a[104:105], v5 offset:10240
    ds_read_b64_tr_b16 a[106:107], v5 offset:11264
    ds_read_b64_tr_b16 a[108:109], v14 offset:10240
    ds_read_b64_tr_b16 a[110:111], v14 offset:11264
    v_lshlrev_b32 v170, 16, v245
    v_mfma_f32_32x32x16_bf16 v[224:239], a[52:55], v[112:115], v[224:239]
    v_and_b32 v171, 0xffff0000, v245
    v_lshlrev_b32 v172, 16, v253
    v_and_b32 v173, 0xffff0000, v253
    v_add_f32 v162, v170, v172
    s_waitcnt vmcnt(5)
    v_mfma_f32_32x32x16_bf16 v[208:223], a[56:59], v[116:119], v[208:223]
    buffer_load_dwordx4 v[92:95], v31, s[32:35], s42 offen sc1
    v_add_f32 v163, v171, v173
    v_lshlrev_b32 v170, 16, v246
    v_mfma_f32_32x32x16_bf16 v[224:239], a[60:63], v[116:119], v[224:239]
    v_and_b32 v171, 0xffff0000, v246
    v_lshlrev_b32 v172, 16, v254
    v_and_b32 v173, 0xffff0000, v254
    s_waitcnt vmcnt(5) lgkmcnt(15)
    v_mfma_f32_32x32x16_bf16 v[208:223], a[64:67], v[72:75], v[208:223]
    buffer_load_dwordx4 v[96:99], v26, s[32:35], s36 offen sc1
    v_add_f32 v164, v170, v172
    v_add_f32 v165, v171, v173
    v_mfma_f32_32x32x16_bf16 v[224:239], a[68:71], v[72:75], v[224:239]
    v_lshlrev_b32 v170, 16, v247
    v_and_b32 v171, 0xffff0000, v247
    v_lshlrev_b32 v172, 16, v255
    s_waitcnt vmcnt(5)
    v_mfma_f32_32x32x16_bf16 v[208:223], a[72:75], v[76:79], v[208:223]
    buffer_load_dwordx4 v[100:103], v26, s[32:35], s37 offen sc1
    v_and_b32 v173, 0xffff0000, v255
    v_add_f32 v166, v170, v172
    v_mfma_f32_32x32x16_bf16 v[224:239], a[76:79], v[76:79], v[224:239]
    v_add_f32 v167, v171, v173
    s_and_b32 s3, s6, 1
    s_lshl_b32 s3, s3, 2
    v_lshrrev_b32 v170, 5, v1
    s_waitcnt vmcnt(5) lgkmcnt(14)
    v_mfma_f32_32x32x16_bf16 v[208:223], a[80:83], v[80:83], v[208:223]
    buffer_load_dwordx4 v[104:107], v26, s[32:35], s38 offen sc1
    v_or_b32 v170, s3, v170
    v_and_b32 v171, 7, v1
    s_waitcnt lgkmcnt(12)
    v_mfma_f32_32x32x16_bf16 v[224:239], a[84:87], v[80:83], v[224:239]
    v_xor_b32 v170, v170, v171
    v_and_b32 v171, 31, v1
    s_lshr_b32 s54, s6, 1
    s_lshl_b32 s54, s54, 12
    s_add_u32 s54, s54, 106496
    s_waitcnt vmcnt(5) lgkmcnt(10)
    v_mfma_f32_32x32x16_bf16 v[208:223], a[88:91], v[84:87], v[208:223]
    buffer_load_dwordx4 v[108:111], v26, s[32:35], s39 offen sc1
    v_lshl_add_u32 v171, v171, 7, s54
    v_lshl_add_u32 v56, v170, 4, v171
    s_waitcnt lgkmcnt(8)
    v_mfma_f32_32x32x16_bf16 v[224:239], a[92:95], v[84:87], v[224:239]
    v_xor_b32 v58, 32, v56
    v_lshrrev_b32 v170, 3, v1
    v_and_b32 v171, 7, v1
    s_waitcnt vmcnt(5) lgkmcnt(6)
    v_mfma_f32_32x32x16_bf16 v[208:223], a[96:99], v[88:91], v[208:223]
    buffer_load_dwordx4 v[112:115], v26, s[32:35], s40 offen sc1
    v_xor_b32 v172, v170, v171
    s_lshl_b32 s3, s3, 2
    s_waitcnt lgkmcnt(4)
    v_mfma_f32_32x32x16_bf16 v[224:239], a[100:103], v[88:91], v[224:239]
    v_add_u32 v170, s3, v170
    v_lshl_add_u32 v173, v170, 7, s54
    v_lshl_add_u32 v57, v172, 4, v173
    s_waitcnt vmcnt(5) lgkmcnt(2)
    v_mfma_f32_32x32x16_bf16 v[208:223], a[104:107], v[92:95], v[208:223]
    buffer_load_dwordx4 v[116:119], v26, s[32:35], s41 offen sc1
    v_mul_u32_u24 v170, 896, v170
    v_lshl_add_u32 v11, v171, 4, v170
    s_waitcnt lgkmcnt(0)
    v_mfma_f32_32x32x16_bf16 v[224:239], a[108:111], v[92:95], v[224:239]
    s_and_b32 s78, s78, -128
    s_add_u32 s55, s78, 7168
    s_waitcnt vmcnt(5)
    v_mfma_f32_32x32x16_bf16 v[176:191], a[0:3], v[96:99], v[176:191]
    buffer_load_dwordx4 v[72:75], v26, s[32:35], s42 offen sc1
    s_nop 1
    ds_write_b128 v21, v[208:211] offset:0
    v_mfma_f32_32x32x16_bf16 v[192:207], a[4:7], v[96:99], v[192:207]
    ds_write_b128 v21, v[212:215] offset:1024
    s_waitcnt vmcnt(5)
    v_mfma_f32_32x32x16_bf16 v[176:191], a[8:11], v[100:103], v[176:191]
    buffer_load_dwordx4 v[76:79], v27, s[32:35], s36 offen sc1
    v_mfma_f32_32x32x16_bf16 v[192:207], a[12:15], v[100:103], v[192:207]
    ds_write_b128 v21, v[216:219] offset:2048
    s_waitcnt vmcnt(5)
    v_mfma_f32_32x32x16_bf16 v[176:191], a[16:19], v[104:107], v[176:191]
    buffer_load_dwordx4 v[80:83], v27, s[32:35], s37 offen sc1
    v_mfma_f32_32x32x16_bf16 v[192:207], a[20:23], v[104:107], v[192:207]
    ds_write_b128 v21, v[220:223] offset:3072
    s_waitcnt vmcnt(5)
    v_mfma_f32_32x32x16_bf16 v[176:191], a[24:27], v[108:111], v[176:191]
    buffer_load_dwordx4 v[84:87], v27, s[32:35], s38 offen sc1
    ds_write_b128 v22, v[224:227] offset:0
    v_mfma_f32_32x32x16_bf16 v[192:207], a[28:31], v[108:111], v[192:207]
    ds_write_b128 v22, v[228:231] offset:1024
    s_waitcnt vmcnt(5)
    v_mfma_f32_32x32x16_bf16 v[176:191], a[32:35], v[112:115], v[176:191]
    buffer_load_dwordx4 v[88:91], v27, s[32:35], s39 offen sc1
    v_mfma_f32_32x32x16_bf16 v[192:207], a[36:39], v[112:115], v[192:207]
    ds_write_b128 v22, v[232:235] offset:2048
    s_waitcnt vmcnt(5)
    v_mfma_f32_32x32x16_bf16 v[176:191], a[40:43], v[116:119], v[176:191]
    buffer_load_dwordx4 v[92:95], v27, s[32:35], s40 offen sc1
    v_mfma_f32_32x32x16_bf16 v[192:207], a[44:47], v[116:119], v[192:207]
    ds_write_b128 v22, v[236:239] offset:3072
    s_waitcnt vmcnt(5)
    v_mfma_f32_32x32x16_bf16 v[176:191], a[48:51], v[72:75], v[176:191]
    buffer_load_dwordx4 v[96:99], v27, s[32:35], s41 offen sc1
    s_waitcnt lgkmcnt(0)
    s_barrier
    ds_read_b128 v[120:123], v23 offset:4096
    v_mfma_f32_32x32x16_bf16 v[192:207], a[52:55], v[72:75], v[192:207]
    ds_read_b128 v[136:139], v23 offset:8192
    ds_read_b128 v[124:127], v23 offset:5120
    ds_read_b128 v[140:143], v23 offset:9216
    s_waitcnt vmcnt(5)
    v_mfma_f32_32x32x16_bf16 v[176:191], a[56:59], v[76:79], v[176:191]
    buffer_load_dwordx4 v[100:103], v27, s[32:35], s42 offen sc1
    ds_read_b128 v[128:131], v23 offset:6144
    ds_read_b128 v[144:147], v23 offset:10240
    v_mfma_f32_32x32x16_bf16 v[192:207], a[60:63], v[76:79], v[192:207]
    ds_read_b128 v[132:135], v23 offset:7168
    ds_read_b128 v[148:151], v23 offset:11264
    s_waitcnt vmcnt(5)
    v_mfma_f32_32x32x16_bf16 v[176:191], a[64:67], v[80:83], v[176:191]
    s_waitcnt lgkmcnt(6)
    v_add_f32 v120, v120, v136
    v_add_f32 v121, v121, v137
    v_add_f32 v122, v122, v138
    v_add_f32 v123, v123, v139
    s_waitcnt lgkmcnt(4)
    v_add_f32 v124, v124, v140
    v_add_f32 v125, v125, v141
    v_add_f32 v126, v126, v142
    v_add_f32 v127, v127, v143
    v_mfma_f32_32x32x16_bf16 v[192:207], a[68:71], v[80:83], v[192:207]
    s_waitcnt lgkmcnt(2)
    v_add_f32 v128, v128, v144
    v_add_f32 v129, v129, v145
    v_add_f32 v130, v130, v146
    v_add_f32 v131, v131, v147
    s_waitcnt lgkmcnt(0)
    v_add_f32 v132, v132, v148
    v_add_f32 v133, v133, v149
    v_add_f32 v134, v134, v150
    v_add_f32 v135, v135, v151
    s_waitcnt vmcnt(4)
    v_mfma_f32_32x32x16_bf16 v[192:207], a[76:79], v[84:87], v[192:207]
    v_fmac_f32 v152, v120, v168
    v_fmac_f32 v153, v121, v168
    v_fmac_f32 v154, v122, v168
    v_fmac_f32 v155, v123, v168
    s_waitcnt vmcnt(3)
    v_mfma_f32_32x32x16_bf16 v[192:207], a[84:87], v[88:91], v[192:207]
    v_fmac_f32 v156, v124, v168
    v_fmac_f32 v157, v125, v168
    v_fmac_f32 v158, v126, v168
    s_waitcnt vmcnt(2)
    v_mfma_f32_32x32x16_bf16 v[192:207], a[92:95], v[92:95], v[192:207]
    v_fmac_f32 v159, v127, v168
    v_fmac_f32 v160, v128, v168
    v_fmac_f32 v161, v129, v168
    s_waitcnt vmcnt(1)
    v_mfma_f32_32x32x16_bf16 v[192:207], a[100:103], v[96:99], v[192:207]
    v_fmac_f32 v162, v130, v168
    v_fmac_f32 v163, v131, v168
    v_fmac_f32 v164, v132, v168
    s_waitcnt vmcnt(0)
    v_mfma_f32_32x32x16_bf16 v[192:207], a[108:111], v[100:103], v[192:207]
    v_fmac_f32 v165, v133, v168
    v_fmac_f32 v166, v134, v168
    v_fmac_f32 v167, v135, v168
    v_mfma_f32_32x32x16_bf16 v[176:191], a[72:75], v[84:87], v[176:191]
    s_lshl_b32 s3, s2, 2
    s_add_u32 s3, s3, s6
    s_cmp_eq_u32 s3, 0
    s_cselect_b32 s3, 0, 1073741824
    v_mov_b32 v39, s59
    s_mov_b64 exec, 1
    buffer_store_dword v39, off, s[32:35], s3 sc1
    s_mov_b64 exec, -1
    v_mfma_f32_32x32x16_bf16 v[176:191], a[80:83], v[88:91], v[176:191]
    ds_write_b128 v20, v[192:195] offset:0
    v_mfma_f32_32x32x16_bf16 v[176:191], a[88:91], v[92:95], v[176:191]
    ds_write_b128 v20, v[196:199] offset:1024
    v_mfma_f32_32x32x16_bf16 v[176:191], a[96:99], v[96:99], v[176:191]
    ds_write_b128 v20, v[200:203] offset:2048
    v_mfma_f32_32x32x16_bf16 v[176:191], a[104:107], v[100:103], v[176:191]
    ds_write_b128 v20, v[204:207] offset:3072
    s_waitcnt lgkmcnt(0)
    s_barrier
    ds_read_b128 v[120:123], v23 offset:0
    ds_read_b128 v[124:127], v23 offset:1024
    ds_read_b128 v[128:131], v23 offset:2048
    ds_read_b128 v[132:135], v23 offset:3072
    s_nop 4
    v_pk_fma_f32 v[152:153], v[176:177], v[168:169], v[152:153] op_sel_hi:[1,0,1]
    v_pk_fma_f32 v[154:155], v[178:179], v[168:169], v[154:155] op_sel_hi:[1,0,1]
    v_pk_fma_f32 v[156:157], v[180:181], v[168:169], v[156:157] op_sel_hi:[1,0,1]
    v_pk_fma_f32 v[158:159], v[182:183], v[168:169], v[158:159] op_sel_hi:[1,0,1]
    v_pk_fma_f32 v[160:161], v[184:185], v[168:169], v[160:161] op_sel_hi:[1,0,1]
    v_pk_fma_f32 v[162:163], v[186:187], v[168:169], v[162:163] op_sel_hi:[1,0,1]
    v_pk_fma_f32 v[164:165], v[188:189], v[168:169], v[164:165] op_sel_hi:[1,0,1]
    v_pk_fma_f32 v[166:167], v[190:191], v[168:169], v[166:167] op_sel_hi:[1,0,1]
    s_waitcnt lgkmcnt(3)
    v_pk_fma_f32 v[152:153], v[120:121], v[168:169], v[152:153] op_sel_hi:[1,0,1]
    v_pk_fma_f32 v[154:155], v[122:123], v[168:169], v[154:155] op_sel_hi:[1,0,1]
    s_waitcnt lgkmcnt(2)
    v_pk_fma_f32 v[156:157], v[124:125], v[168:169], v[156:157] op_sel_hi:[1,0,1]
    v_pk_fma_f32 v[158:159], v[126:127], v[168:169], v[158:159] op_sel_hi:[1,0,1]
    v_cvt_pk_bf16_f32 v136, v152, v153
    v_cvt_pk_bf16_f32 v137, v154, v155
    v_cvt_pk_bf16_f32 v138, v156, v157
    v_cvt_pk_bf16_f32 v139, v158, v159
    s_nop 0
    v_permlane32_swap_b32 v136, v138
    v_permlane32_swap_b32 v137, v139
    ds_write_b128 v56, v[136:139]
    s_waitcnt lgkmcnt(2)
    v_pk_fma_f32 v[160:161], v[128:129], v[168:169], v[160:161] op_sel_hi:[1,0,1]
    v_pk_fma_f32 v[162:163], v[130:131], v[168:169], v[162:163] op_sel_hi:[1,0,1]
    s_waitcnt lgkmcnt(1)
    v_pk_fma_f32 v[164:165], v[132:133], v[168:169], v[164:165] op_sel_hi:[1,0,1]
    v_pk_fma_f32 v[166:167], v[134:135], v[168:169], v[166:167] op_sel_hi:[1,0,1]
    v_cvt_pk_bf16_f32 v140, v160, v161
    v_cvt_pk_bf16_f32 v141, v162, v163
    v_cvt_pk_bf16_f32 v142, v164, v165
    v_cvt_pk_bf16_f32 v143, v166, v167
    s_nop 0
    v_permlane32_swap_b32 v140, v142
    v_permlane32_swap_b32 v141, v143
    ds_write_b128 v58, v[140:143]
    s_waitcnt lgkmcnt(0)
    s_barrier
    ds_read_b128 v[120:123], v57 offset:0
    ds_read_b128 v[124:127], v57 offset:1024
    s_waitcnt lgkmcnt(1)
    buffer_store_dwordx4 v[120:123], v11, s[28:31], s78 offen nt
    s_waitcnt lgkmcnt(0)
    buffer_store_dwordx4 v[124:127], v11, s[28:31], s55 offen nt
    s_endpgm
L_spare:
    s_nop 4
    ds_read_b64_tr_b16 a[140:141], v10 offset:3072
    ds_read_b64_tr_b16 a[142:143], v10 offset:3328
    ds_read_b64_tr_b16 a[144:145], v10 offset:4096
    ds_read_b64_tr_b16 a[146:147], v10 offset:4352
    ds_read_b64_tr_b16 a[148:149], v10 offset:5120
    ds_read_b64_tr_b16 a[150:151], v10 offset:5376
    s_lshl_b32 s3, s5, 2
    s_add_u32 s3, s3, s6
    s_and_b32 s3, s3, 15
    s_lshl_b32 s3, s3, 6
    v_add_u32 v4, s3, v1
    s_movk_i32 s3, 18725
    v_mul_lo_u32 v5, v4, s3
    v_lshrrev_b32 v5, 22, v5
    v_mul_u32_u24 v5, 672, v5
    v_add_lshl_u32 v32, v5, v4, 7
    v_add_u32 v4, 1024, v4
    v_mul_lo_u32 v5, v4, s3
    v_lshrrev_b32 v5, 22, v5
    v_mul_u32_u24 v5, 672, v5
    v_add_lshl_u32 v33, v5, v4, 7
    v_add_u32 v4, 1024, v4
    v_mul_lo_u32 v5, v4, s3
    v_lshrrev_b32 v5, 22, v5
    v_mul_u32_u24 v5, 672, v5
    v_add_lshl_u32 v34, v5, v4, 7
    v_add_u32 v4, 1024, v4
    v_mul_lo_u32 v5, v4, s3
    v_lshrrev_b32 v5, 22, v5
    v_mul_u32_u24 v5, 672, v5
    v_add_lshl_u32 v35, v5, v4, 7
    v_add_u32 v4, 1024, v4
    s_mul_i32 s54, s4, 917504
    v_min_u32 v5, 831360, v33
    v_lshlrev_b32 v7, 5, v4
    s_lshl_b32 s55, s4, 15
    s_add_u32 s55, s55, 0
    s_waitcnt lgkmcnt(10)
    v_mfma_f32_32x32x16_bf16 v[64:79], a[128:131], v[144:147], 0
    ds_read_b64_tr_b16 a[152:153], v10 offset:6144
    ds_read_b64_tr_b16 a[154:155], v10 offset:6400
    v_lshlrev_b32 v85, 11, v1
    v_and_b32 v84, 15, v1
    v_lshl_add_u32 v84, v84, 2, s74
    v_add_u32 v87, s65, v10
    v_lshrrev_b32 v104, 5, v1
    v_mul_u32_u24 v104, 384, v104
    s_waitcnt lgkmcnt(10)
    v_mfma_f32_32x32x16_bf16 v[64:79], a[132:135], v[148:151], v[64:79]
    ds_read_b64_tr_b16 a[156:157], v10 offset:7168
    ds_read_b64_tr_b16 a[158:159], v10 offset:7424
    v_accvgpr_read_b32 v86, a202
    v_cndmask_b32_e64 v84, v84, v86, s[48:49]
    v_lshl_add_u32 v104, v1, 2, v104
    v_add_u32 v104, 160768, v104
    s_lshl_b32 s47, s6, 8
    s_add_u32 s47, s47, 160768
    v_lshl_add_u32 v105, v1, 2, s47
    s_waitcnt lgkmcnt(10)
    v_mfma_f32_32x32x16_bf16 v[64:79], a[136:139], v[152:155], v[64:79]
    ds_read_b64_tr_b16 a[160:161], v10 offset:8192
    ds_read_b64_tr_b16 a[162:163], v10 offset:8448
    v_mov_b32 v47, 0
    s_sub_u32 s67, s67, s65
    ds_read_b64_tr_b16 a[64:65], v87 offset:0
    ds_read_b64_tr_b16 a[66:67], v87 offset:256
    s_waitcnt lgkmcnt(12)
    v_mfma_f32_32x32x16_bf16 v[64:79], a[140:143], v[156:159], v[64:79]
    ds_read_b64_tr_b16 a[164:165], v10 offset:9216
    ds_read_b64_tr_b16 a[166:167], v10 offset:9472
    s_waitcnt lgkmcnt(12)
    v_mfma_f32_32x32x16_bf16 v[64:79], a[144:147], v[160:163], v[64:79]
    ds_read_b64_tr_b16 a[168:169], v10 offset:10240
    ds_read_b64_tr_b16 a[170:171], v10 offset:10496
    ds_read_b64_tr_b16 a[68:69], v87 offset:4096
    ds_read_b64_tr_b16 a[70:71], v87 offset:4352
    s_waitcnt lgkmcnt(14)
    v_mfma_f32_32x32x16_bf16 v[64:79], a[148:151], v[164:167], v[64:79]
    ds_read_b64_tr_b16 a[172:173], v10 offset:11264
    ds_read_b64_tr_b16 a[174:175], v10 offset:11520
    s_waitcnt lgkmcnt(14)
    v_mfma_f32_32x32x16_bf16 v[64:79], a[152:155], v[168:171], v[64:79]
    ds_read_b64_tr_b16 a[176:177], v10 offset:12288
    ds_read_b64_tr_b16 a[178:179], v10 offset:12544
    v_cvt_pk_bf16_f32 v88, -v106, -v106
    v_mov_b32 v89, v88
    s_waitcnt lgkmcnt(10)
    v_mfma_f32_16x16x32_bf16 v[24:27], v[16:19], a[64:67], 0
    ds_read_b64_tr_b16 a[72:73], v87 offset:8192
    ds_read_b64_tr_b16 a[74:75], v87 offset:8448
    v_mfma_f32_32x32x16_bf16 v[64:79], a[156:159], v[172:175], v[64:79]
    ds_read_b64_tr_b16 a[180:181], v10 offset:13312
    ds_read_b64_tr_b16 a[182:183], v10 offset:13568
    v_mfma_f32_32x32x16_bf16 v[64:79], a[160:163], v[176:179], v[64:79]
    ds_read_b64_tr_b16 a[184:185], v10 offset:14336
    ds_read_b64_tr_b16 a[186:187], v10 offset:14592
    s_waitcnt vmcnt(0)
    s_barrier
    s_mov_b64 exec, 0xff
    buffer_store_dword v3, v85, s[32:35], s68 offen sc1
    s_mov_b64 exec, -1
    s_waitcnt lgkmcnt(10)
    v_mfma_f32_16x16x32_bf16 v[24:27], v[16:19], a[68:71], v[24:27]
    ds_read_b64_tr_b16 a[76:77], v87 offset:12288
    ds_read_b64_tr_b16 a[78:79], v87 offset:12544
    v_mfma_f32_32x32x16_bf16 v[64:79], a[164:167], v[180:183], v[64:79]
    ds_read_b64_tr_b16 a[188:189], v10 offset:15360
    ds_read_b64_tr_b16 a[190:191], v10 offset:15616
    v_mfma_f32_32x32x16_bf16 v[64:79], a[168:171], v[184:187], v[64:79]
    ds_read_b64_tr_b16 a[128:129], v10 offset:16384
    ds_read_b64_tr_b16 a[130:131], v10 offset:16640
    s_waitcnt lgkmcnt(10)
    v_mfma_f32_16x16x32_bf16 v[24:27], v[16:19], a[72:75], v[24:27]
    ds_read_b64_tr_b16 a[80:81], v87 offset:16384
    ds_read_b64_tr_b16 a[82:83], v87 offset:16640
    v_mfma_f32_32x32x16_bf16 v[64:79], a[172:175], v[188:191], v[64:79]
    ds_read_b64_tr_b16 a[132:133], v10 offset:17408
    ds_read_b64_tr_b16 a[134:135], v10 offset:17664
    v_mfma_f32_32x32x16_bf16 v[64:79], a[176:179], v[192:195], v[64:79]
    ds_read_b64_tr_b16 a[136:137], v10 offset:18432
    ds_read_b64_tr_b16 a[138:139], v10 offset:18688
    s_waitcnt lgkmcnt(10)
    v_mfma_f32_16x16x32_bf16 v[24:27], v[16:19], a[76:79], v[24:27]
    ds_read_b64_tr_b16 a[84:85], v87 offset:20480
    ds_read_b64_tr_b16 a[86:87], v87 offset:20736
    v_mfma_f32_32x32x16_bf16 v[64:79], a[180:183], v[196:199], v[64:79]
    ds_read_b64_tr_b16 a[140:141], v10 offset:19456
    ds_read_b64_tr_b16 a[142:143], v10 offset:19712
    v_mfma_f32_32x32x16_bf16 v[64:79], a[184:187], v[200:203], v[64:79]
    ds_read_b64_tr_b16 a[144:145], v10 offset:20480
    ds_read_b64_tr_b16 a[146:147], v10 offset:20736
    s_waitcnt lgkmcnt(10)
    v_mfma_f32_16x16x32_bf16 v[24:27], v[16:19], a[80:83], v[24:27]
    ds_read_b64_tr_b16 a[88:89], v87 offset:24576
    ds_read_b64_tr_b16 a[90:91], v87 offset:24832
    v_mfma_f32_32x32x16_bf16 v[64:79], a[188:191], v[204:207], v[64:79]
    ds_read_b64_tr_b16 a[148:149], v10 offset:21504
    ds_read_b64_tr_b16 a[150:151], v10 offset:21760
    v_mfma_f32_32x32x16_bf16 v[64:79], a[128:131], v[208:211], v[64:79]
    ds_read_b64_tr_b16 a[152:153], v10 offset:22528
    ds_read_b64_tr_b16 a[154:155], v10 offset:22784
    s_waitcnt lgkmcnt(10)
    v_mfma_f32_16x16x32_bf16 v[24:27], v[16:19], a[84:87], v[24:27]
    v_mfma_f32_32x32x16_bf16 v[64:79], a[132:135], v[212:215], v[64:79]
    ds_read_b64_tr_b16 a[156:157], v10 offset:23552
    ds_read_b64_tr_b16 a[158:159], v10 offset:23808
    v_mfma_f32_32x32x16_bf16 v[64:79], a[136:139], v[216:219], v[64:79]
    ds_read_b64_tr_b16 a[160:161], v10 offset:24576
    ds_read_b64_tr_b16 a[162:163], v10 offset:24832
    s_waitcnt lgkmcnt(8)
    v_mfma_f32_16x16x32_bf16 v[24:27], v[16:19], a[88:91], v[24:27]
    v_mfma_f32_32x32x16_bf16 v[64:79], a[140:143], v[220:223], v[64:79]
    ds_read_b64_tr_b16 a[164:165], v10 offset:25600
    ds_read_b64_tr_b16 a[166:167], v10 offset:25856
    v_mfma_f32_32x32x16_bf16 v[64:79], a[144:147], v[224:227], v[64:79]
    ds_read_b64_tr_b16 a[168:169], v10 offset:26624
    ds_read_b64_tr_b16 a[170:171], v10 offset:26880
    s_nop 1
    v_cvt_pk_bf16_f32 v80, v24, v24
    v_and_b32 v80, 0xffff0000, v80
    v_sub_f32 v92, v24, v80
    s_waitcnt lgkmcnt(10)
    v_mfma_f32_32x32x16_bf16 v[64:79], a[148:151], v[228:231], v[64:79]
    ds_read_b64_tr_b16 a[172:173], v10 offset:27648
    ds_read_b64_tr_b16 a[174:175], v10 offset:27904
    v_cvt_pk_bf16_f32 v92, v80, v92
    ds_write_b32 v105, v92
    s_waitcnt lgkmcnt(11)
    v_mfma_f32_32x32x16_bf16 v[64:79], a[152:155], v[232:235], v[64:79]
    s_waitcnt lgkmcnt(9)
    v_mfma_f32_32x32x16_bf16 v[64:79], a[156:159], v[236:239], v[64:79]
    s_waitcnt lgkmcnt(7)
    v_mfma_f32_32x32x16_bf16 v[64:79], a[160:163], v[240:243], v[64:79]
    s_waitcnt lgkmcnt(0)
    s_barrier
    ds_read2st64_b32 v[92:93], v104 offset0:0 offset1:1
    v_mfma_f32_32x32x16_bf16 v[64:79], a[164:167], v[244:247], v[64:79]
    v_mfma_f32_32x32x16_bf16 v[64:79], a[168:171], v[248:251], v[64:79]
    v_mfma_f32_32x32x16_bf16 v[64:79], a[172:175], v[252:255], v[64:79]
    s_waitcnt lgkmcnt(0)
    v_mfma_f32_32x32x16_bf16 v[64:79], v[92:95], v[88:91], v[64:79]
    s_nop 11
    v_pk_mul_f32 v[64:65], v[64:65], v[108:109] op_sel_hi:[1,0]
    v_pk_mul_f32 v[66:67], v[66:67], v[108:109] op_sel_hi:[1,0]
    v_pk_mul_f32 v[68:69], v[68:69], v[108:109] op_sel_hi:[1,0]
    v_pk_mul_f32 v[70:71], v[70:71], v[108:109] op_sel_hi:[1,0]
    v_pk_mul_f32 v[72:73], v[72:73], v[108:109] op_sel_hi:[1,0]
    v_pk_mul_f32 v[74:75], v[74:75], v[108:109] op_sel_hi:[1,0]
    v_pk_mul_f32 v[76:77], v[76:77], v[108:109] op_sel_hi:[1,0]
    v_pk_mul_f32 v[78:79], v[78:79], v[108:109] op_sel_hi:[1,0]
    v_exp_f32_e64 v112, v64 clamp
    v_max_f32 v64, 0x35c1a2a0, v64
    v_exp_f32_e64 v113, v65 clamp
    v_max_f32 v65, 0x35c1a2a0, v65
    v_exp_f32_e64 v114, v66 clamp
    v_max_f32 v66, 0x35c1a2a0, v66
    v_exp_f32_e64 v115, v67 clamp
    v_max_f32 v67, 0x35c1a2a0, v67
    v_exp_f32_e64 v116, v68 clamp
    v_max_f32 v68, 0x35c1a2a0, v68
    v_exp_f32_e64 v117, v69 clamp
    v_max_f32 v69, 0x35c1a2a0, v69
    v_exp_f32_e64 v118, v70 clamp
    v_max_f32 v70, 0x35c1a2a0, v70
    v_exp_f32_e64 v119, v71 clamp
    v_max_f32 v71, 0x35c1a2a0, v71
    buffer_load_dword v102, v84, s[32:35], 0 offen sc1
    v_pk_fma_f32 v[112:113], v[64:65], s[58:59], v[112:113] op_sel_hi:[1,0,1]
    v_pk_fma_f32 v[114:115], v[66:67], s[58:59], v[114:115] op_sel_hi:[1,0,1]
    v_pk_fma_f32 v[116:117], v[68:69], s[58:59], v[116:117] op_sel_hi:[1,0,1]
    v_pk_fma_f32 v[118:119], v[70:71], s[58:59], v[118:119] op_sel_hi:[1,0,1]
    v_cvt_pk_bf16_f32 v128, v112, v113
    v_cvt_pk_bf16_f32 v129, v114, v115
    v_cvt_pk_bf16_f32 v130, v116, v117
    v_cvt_pk_bf16_f32 v131, v118, v119
    v_exp_f32_e64 v120, v72 clamp
    v_max_f32 v72, 0x35c1a2a0, v72
    v_exp_f32_e64 v121, v73 clamp
    v_max_f32 v73, 0x35c1a2a0, v73
    v_exp_f32_e64 v122, v74 clamp
    v_max_f32 v74, 0x35c1a2a0, v74
    v_exp_f32_e64 v123, v75 clamp
    v_max_f32 v75, 0x35c1a2a0, v75
    v_exp_f32_e64 v124, v76 clamp
    v_max_f32 v76, 0x35c1a2a0, v76
    v_exp_f32_e64 v125, v77 clamp
    v_max_f32 v77, 0x35c1a2a0, v77
    v_exp_f32_e64 v126, v78 clamp
    v_max_f32 v78, 0x35c1a2a0, v78
    v_exp_f32_e64 v127, v79 clamp
    v_max_f32 v79, 0x35c1a2a0, v79
    v_pk_fma_f32 v[120:121], v[72:73], s[58:59], v[120:121] op_sel_hi:[1,0,1]
    v_pk_fma_f32 v[122:123], v[74:75], s[58:59], v[122:123] op_sel_hi:[1,0,1]
    v_pk_fma_f32 v[124:125], v[76:77], s[58:59], v[124:125] op_sel_hi:[1,0,1]
    v_pk_fma_f32 v[126:127], v[78:79], s[58:59], v[126:127] op_sel_hi:[1,0,1]
    v_cvt_pk_bf16_f32 v132, v120, v121
    v_cvt_pk_bf16_f32 v133, v122, v123
    v_cvt_pk_bf16_f32 v134, v124, v125
    v_cvt_pk_bf16_f32 v135, v126, v127
    s_waitcnt vmcnt(0)
    v_and_b32 v103, -8, v102
    v_cmp_ne_u32 vcc, s7, v103
    s_cbranch_vccz Ldone_18
    s_mov_b32 s56, 0x100000
Lpoll_17:
    buffer_load_dword v102, v84, s[32:35], 0 offen sc1
    s_waitcnt vmcnt(0)
    v_and_b32 v103, -8, v102
    v_cmp_ne_u32 vcc, s7, v103
    s_cbranch_vccz Ldone_18
    s_sub_u32 s56, s56, 1
    s_cbranch_scc0 Lpoll_17
Ldone_18:
    buffer_load_dwordx4 v[48:51], v2, s[32:35], s67 offen offset:0 sc1
    buffer_load_dwordx4 v[52:55], v2, s[32:35], s67 offen offset:1024 sc1
    buffer_load_dwordx4 v[56:59], v2, s[32:35], s67 offen offset:2048 sc1
    buffer_load_dwordx4 v[60:63], v2, s[32:35], s67 offen offset:3072 sc1
    v_cmp_ne_u32 vcc, s60, v102
    s_nop 0
    s_cmp_eq_u32 vcc_lo, 0
    s_cselect_b32 s57, 1, 0
    s_waitcnt vmcnt(3)
    v_cvt_pk_bf16_f32 v48, v48, v49
    v_cvt_pk_bf16_f32 v49, v50, v51
    s_waitcnt vmcnt(2)
    v_cvt_pk_bf16_f32 v50, v52, v53
    v_cvt_pk_bf16_f32 v51, v54, v55
    s_waitcnt vmcnt(1)
    v_cvt_pk_bf16_f32 v52, v56, v57
    v_cvt_pk_bf16_f32 v53, v58, v59
    s_waitcnt vmcnt(0)
    v_cvt_pk_bf16_f32 v54, v60, v61
    v_cvt_pk_bf16_f32 v55, v62, v63
    v_mfma_f32_32x32x16_bf16 v[64:79], v[48:51], v[128:131], 0
    s_nop 0
    v_mfma_f32_32x32x16_bf16 v[64:79], v[52:55], v[132:135], v[64:79]
    s_nop 11
    v_add_f32 v78, 0x358637bd, v78
    v_rcp_f32 v78, v78
    s_nop 0
    v_pk_mul_f32 v[64:65], v[64:65], v[78:79] op_sel_hi:[1,0]
    v_pk_mul_f32 v[66:67], v[66:67], v[78:79] op_sel_hi:[1,0]
    v_pk_mul_f32 v[68:69], v[68:69], v[78:79] op_sel_hi:[1,0]
    v_pk_mul_f32 v[70:71], v[70:71], v[78:79] op_sel_hi:[1,0]
    v_pk_mul_f32 v[72:73], v[72:73], v[78:79] op_sel_hi:[1,0]
    v_pk_mul_f32 v[74:75], v[74:75], v[78:79] op_sel_hi:[1,0]
    v_pk_mul_f32 v[76:77], v[76:77], v[78:79] op_sel_hi:[1,0]
    v_cvt_pk_bf16_f32 v40, v64, v65
    v_cvt_pk_bf16_f32 v41, v66, v67
    v_cvt_pk_bf16_f32 v42, v68, v69
    v_cvt_pk_bf16_f32 v43, v70, v71
    v_cvt_pk_bf16_f32 v44, v72, v73
    v_cvt_pk_bf16_f32 v45, v74, v75
    v_cvt_pk_bf16_f32 v46, v76, v77
    s_cmp_eq_u32 s57, 1
    s_cbranch_scc0 Lslow_19
    buffer_store_dwordx4 v[40:43], v2, s[32:35], s69 offen
    buffer_store_dwordx4 v[44:47], v2, s[32:35], s69 offen offset:1024
Lend_20:
    s_waitcnt vmcnt(0)
    s_mov_b64 exec, 1
    s_cmp_eq_u32 s57, 1
    s_cbranch_scc0 Lslow_21
    buffer_store_dword v3, off, s[32:35], s70
Lend_22:
    s_mov_b64 exec, -1
    s_barrier
    s_cmp_eq_u32 s57, 1
    s_cselect_b32 s54, s54, 1073741824
    s_cselect_b32 s55, s55, 1073741824
    s_mov_b32 s52, 0
    buffer_load_dword v110, v32, s[24:27], s52 offen
    s_mov_b32 s52, 0
    buffer_load_dword v110, v33, s[24:27], s52 offen
    s_mov_b32 s52, 0
    buffer_load_dword v110, v34, s[24:27], s52 offen
    s_mov_b32 s52, 0
    buffer_load_dword v110, v35, s[24:27], s52 offen
    s_mov_b32 s52, 28672
    buffer_load_dword v110, v32, s[24:27], s52 offen
    s_mov_b32 s52, 28672
    buffer_load_dword v110, v33, s[24:27], s52 offen
    s_mov_b32 s52, 28672
    buffer_load_dword v110, v34, s[24:27], s52 offen
    s_mov_b32 s52, 28672
    buffer_load_dword v110, v35, s[24:27], s52 offen
    s_add_u32 s52, s54, 4222976
    buffer_load_dword v110, v32, s[32:35], s52 offen sc1
    s_add_u32 s52, s54, 4222976
    buffer_load_dword v110, v5, s[32:35], s52 offen sc1
    s_mov_b32 s52, 57344
    buffer_load_dword v110, v32, s[24:27], s52 offen
    s_mov_b32 s52, 57344
    buffer_load_dword v110, v33, s[24:27], s52 offen
    s_mov_b32 s52, 57344
    buffer_load_dword v110, v34, s[24:27], s52 offen
    s_mov_b32 s52, 57344
    buffer_load_dword v110, v35, s[24:27], s52 offen
    s_add_u32 s52, s54, 4251648
    buffer_load_dword v110, v32, s[32:35], s52 offen sc1
    s_add_u32 s52, s54, 4251648
    buffer_load_dword v110, v5, s[32:35], s52 offen sc1
    s_mov_b32 s52, 86016
    buffer_load_dword v110, v32, s[24:27], s52 offen
    s_mov_b32 s52, 86016
    buffer_load_dword v110, v33, s[24:27], s52 offen
    s_mov_b32 s52, 86016
    buffer_load_dword v110, v34, s[24:27], s52 offen
    s_mov_b32 s52, 86016
    buffer_load_dword v110, v35, s[24:27], s52 offen
L_exit:
    s_endpgm
Lslow_19:
    buffer_store_dwordx4 v[40:43], v2, s[32:35], s69 offen sc1
    buffer_store_dwordx4 v[44:47], v2, s[32:35], s69 offen offset:1024 sc1
    s_branch Lend_20
Lslow_21:
    buffer_store_dword v3, off, s[32:35], s70 sc1
    s_branch Lend_22
L_code_end:
L_slowtail:
    ds_read_b64_tr_b16 a[0:1], v28 offset:0
    ds_read_b64_tr_b16 a[2:3], v28 offset:512
    ds_read_b64_tr_b16 a[4:5], v29 offset:0
    ds_read_b64_tr_b16 a[6:7], v29 offset:512
    ds_read_b64_tr_b16 a[8:9], v28 offset:1024
    ds_read_b64_tr_b16 a[10:11], v30 offset:1536
    ds_read_b64_tr_b16 a[12:13], v29 offset:1024
    ds_read_b64_tr_b16 a[14:15], v31 offset:1536
    ds_read_b64_tr_b16 a[16:17], v28 offset:7168
    ds_read_b64_tr_b16 a[18:19], v28 offset:7680
    ds_read_b64_tr_b16 a[20:21], v29 offset:7168
    ds_read_b64_tr_b16 a[22:23], v29 offset:7680
    ds_read_b64_tr_b16 a[24:25], v28 offset:8192
    ds_read_b64_tr_b16 a[26:27], v30 offset:8704
    ds_read_b64_tr_b16 a[28:29], v29 offset:8192
    ds_read_b64_tr_b16 a[30:31], v31 offset:8704
    ds_read_b64_tr_b16 a[32:33], v28 offset:14336
    ds_read_b64_tr_b16 a[34:35], v28 offset:14848
    ds_read_b64_tr_b16 a[36:37], v29 offset:14336
    ds_read_b64_tr_b16 a[38:39], v29 offset:14848
    ds_read_b64_tr_b16 a[40:41], v28 offset:15360
    ds_read_b64_tr_b16 a[42:43], v30 offset:15872
    s_add_u32 m0, s65, 49152
    s_add_u32 s52, s73, 1376256
    buffer_load_dwordx4 v4, s[20:23], s52 offen lds
    ds_read_b64_tr_b16 a[44:45], v29 offset:15360
    ds_read_b64_tr_b16 a[46:47], v31 offset:15872
    ds_read_b64_tr_b16 a[48:49], v28 offset:21504
    ds_read_b64_tr_b16 a[50:51], v28 offset:22016
    ds_read_b64_tr_b16 a[52:53], v29 offset:21504
    ds_read_b64_tr_b16 a[54:55], v29 offset:22016
    ds_read_b64_tr_b16 a[56:57], v28 offset:22528
    ds_read_b64_tr_b16 a[58:59], v30 offset:23040
    ds_read_b64_tr_b16 a[60:61], v29 offset:22528
    ds_read_b64_tr_b16 a[62:63], v31 offset:23040
    s_mul_i32 s3, s79, 7168
    s_sub_u32 s3, s3, 3584
    v_add_u32 v28, s3, v28
    v_add_u32 v29, s3, v29
    v_add_u32 v30, s3, v30
    v_add_u32 v31, s3, v31
    ds_read_b64_tr_b16 a[64:65], v28 offset:0
    ds_read_b64_tr_b16 a[66:67], v28 offset:512
    ds_read_b64_tr_b16 a[68:69], v29 offset:0
    ds_read_b64_tr_b16 a[70:71], v29 offset:512
    ds_read_b64_tr_b16 a[72:73], v28 offset:1024
    ds_read_b64_tr_b16 a[74:75], v30 offset:1536
    ds_read_b64_tr_b16 a[76:77], v29 offset:1024
    ds_read_b64_tr_b16 a[78:79], v31 offset:1536
    ds_read_b64_tr_b16 a[80:81], v28 offset:7168
    ds_read_b64_tr_b16 a[82:83], v28 offset:7680
    ds_read_b64_tr_b16 a[84:85], v29 offset:7168
    s_add_u32 m0, s65, 53248
    s_add_u32 s52, s73, 1490944
    buffer_load_dwordx4 v4, s[20:23], s52 offen lds
    ds_read_b64_tr_b16 a[86:87], v29 offset:7680
    ds_read_b64_tr_b16 a[88:89], v28 offset:8192
    ds_read_b64_tr_b16 a[90:91], v30 offset:8704
    ds_read_b64_tr_b16 a[92:93], v29 offset:8192
    ds_read_b64_tr_b16 a[94:95], v31 offset:8704
    ds_read_b64_tr_b16 a[96:97], v28 offset:14336
    ds_read_b64_tr_b16 a[98:99], v28 offset:14848
    ds_read_b64_tr_b16 a[100:101], v29 offset:14336
    ds_read_b64_tr_b16 a[102:103], v29 offset:14848
    ds_read_b64_tr_b16 a[104:105], v28 offset:15360
    ds_read_b64_tr_b16 a[106:107], v30 offset:15872
    ds_read_b64_tr_b16 a[108:109], v29 offset:15360
    ds_read_b64_tr_b16 a[110:111], v31 offset:15872
    ds_read_b64_tr_b16 a[112:113], v28 offset:21504
    ds_read_b64_tr_b16 a[114:115], v28 offset:22016
    ds_read_b64_tr_b16 a[116:117], v29 offset:21504
    ds_read_b64_tr_b16 a[118:119], v29 offset:22016
    ds_read_b64_tr_b16 a[120:121], v28 offset:22528
    ds_read_b64_tr_b16 a[122:123], v30 offset:23040
    ds_read_b64_tr_b16 a[124:125], v29 offset:22528
    ds_read_b64_tr_b16 a[126:127], v31 offset:23040
    s_add_u32 m0, s83, 4096
    v_add_u32 v15, 6144, v7
    buffer_load_dwordx4 v7, s[24:27], s90 offen lds
    buffer_load_dwordx4 v15, s[24:27], s90 offen offset:1024 lds
    s_waitcnt vmcnt(7)
    v_cvt_pk_bf16_f32 v48, v48, v49
    v_cvt_pk_bf16_f32 v49, v50, v51
    s_waitcnt vmcnt(6)
    v_cvt_pk_bf16_f32 v50, v52, v53
    v_cvt_pk_bf16_f32 v51, v54, v55
    s_waitcnt vmcnt(5)
    v_cvt_pk_bf16_f32 v52, v56, v57
    v_cvt_pk_bf16_f32 v53, v58, v59
    s_waitcnt vmcnt(4)
    v_cvt_pk_bf16_f32 v54, v60, v61
    v_cvt_pk_bf16_f32 v55, v62, v63
    v_mfma_f32_32x32x16_bf16 v[64:79], v[48:51], v[128:131], 0
    s_nop 0
    v_mfma_f32_32x32x16_bf16 v[64:79], v[52:55], v[132:135], v[64:79]
    s_nop 11
    v_add_f32 v78, 0x358637bd, v78
    v_rcp_f32 v78, v78
    s_nop 0
    v_pk_mul_f32 v[64:65], v[64:65], v[78:79] op_sel_hi:[1,0]
    v_pk_mul_f32 v[66:67], v[66:67], v[78:79] op_sel_hi:[1,0]
    v_pk_mul_f32 v[68:69], v[68:69], v[78:79] op_sel_hi:[1,0]
    v_pk_mul_f32 v[70:71], v[70:71], v[78:79] op_sel_hi:[1,0]
    v_pk_mul_f32 v[72:73], v[72:73], v[78:79] op_sel_hi:[1,0]
    v_pk_mul_f32 v[74:75], v[74:75], v[78:79] op_sel_hi:[1,0]
    v_pk_mul_f32 v[76:77], v[76:77], v[78:79] op_sel_hi:[1,0]
    v_cvt_pk_bf16_f32 v40, v64, v65
    v_cvt_pk_bf16_f32 v41, v66, v67
    v_cvt_pk_bf16_f32 v42, v68, v69
    v_cvt_pk_bf16_f32 v43, v70, v71
    v_cvt_pk_bf16_f32 v44, v72, v73
    v_cvt_pk_bf16_f32 v45, v74, v75
    v_cvt_pk_bf16_f32 v46, v76, v77
    buffer_store_dwordx4 v[40:43], v2, s[32:35], s69 offen sc1
    buffer_store_dwordx4 v[44:47], v2, s[32:35], s69 offen offset:1024 sc1
    v_accvgpr_read_b32 v248, a208
    v_accvgpr_read_b32 v249, a209
    v_accvgpr_read_b32 v250, a210
    v_accvgpr_read_b32 v251, a211
    v_accvgpr_read_b32 v252, a212
    v_accvgpr_read_b32 v253, a213
    v_accvgpr_read_b32 v254, a214
    v_accvgpr_read_b32 v255, a215
    v_accvgpr_read_b32 v10, a199
    v_accvgpr_read_b32 v177, a216
    v_lshlrev_b32 v176, 16, v177
    v_and_b32 v177, 0xffff0000, v177
    v_accvgpr_read_b32 v179, a217
    v_lshlrev_b32 v178, 16, v179
    v_and_b32 v179, 0xffff0000, v179
    v_accvgpr_read_b32 v181, a218
    v_lshlrev_b32 v180, 16, v181
    v_and_b32 v181, 0xffff0000, v181
    v_accvgpr_read_b32 v183, a219
    v_lshlrev_b32 v182, 16, v183
    v_and_b32 v183, 0xffff0000, v183
    v_accvgpr_read_b32 v185, a220
    v_lshlrev_b32 v184, 16, v185
    v_and_b32 v185, 0xffff0000, v185
    v_accvgpr_read_b32 v187, a221
    v_lshlrev_b32 v186, 16, v187
    v_and_b32 v187, 0xffff0000, v187
    v_accvgpr_read_b32 v189, a222
    v_lshlrev_b32 v188, 16, v189
    v_and_b32 v189, 0xffff0000, v189
    v_accvgpr_read_b32 v191, a223
    v_lshlrev_b32 v190, 16, v191
    v_and_b32 v191, 0xffff0000, v191
    v_add_u32 v240, 57344, v20
    v_add_u32 v241, 57344, v21
    v_add_u32 v242, 57344, v22
    v_add_u32 v243, 57344, v23
    s_add_u32 m0, s83, 6144
    s_nop 0
    buffer_load_dwordx4 v7, s[24:27], s91 offen lds
    buffer_load_dwordx4 v15, s[24:27], s91 offen offset:1024 lds
    s_lshr_b32 s3, s6, 1
    s_mul_i32 s3, s3, 28672
    v_add_u32 v244, s3, v5
    s_and_b32 s3, s6, 1
    s_lshl_b32 s3, s3, 6
    v_xor_b32 v172, s3, v5
    v_xor_b32 v173, 64, v172
    v_add_u32 v174, 57344, v172
    v_add_u32 v175, 57344, v173
    s_sub_u32 s3, s72, 57344
    v_add_u32 v5, s3, v5
    v_xor_b32 v14, 64, v5
    v_accvgpr_read_b32 v153, a224
    v_mov_b32 v154, 0
    v_mov_b32 v155, 0
    v_accvgpr_read_b32 v157, a225
    v_mov_b32 v158, 0
    v_mov_b32 v159, 0
    v_accvgpr_read_b32 v161, a226
    v_mov_b32 v162, 0
    v_mov_b32 v163, 0
    v_accvgpr_read_b32 v165, a227
    v_mov_b32 v166, 0
    v_mov_b32 v167, 0
    v_mov_b32 v170, 0
    v_mov_b32 v171, 0
    v_mov_b32 v246, 0x3f803f80
    s_or_b32 s60, s7, 1
    v_mov_b32 v247, s60
    s_mul_i32 s3, s79, 14336
    s_add_u32 s54, s76, s3
    s_add_u32 s54, s54, 2048
    s_xor_b32 s55, s54, 2048
    v_and_b32 v245, 7, v1
    v_lshlrev_b32 v245, 2, v245
    s_cmp_eq_u32 s79, 0
    s_mov_b32 s44, 0xaaaaaaaa
    s_cselect_b32 s44, s44, 0x55555555
    s_mov_b32 s45, s44
    s_add_u32 m0, s83, 8192
    s_nop 0
    buffer_load_dwordx4 v7, s[24:27], s92 offen lds
    buffer_load_dwordx4 v15, s[24:27], s92 offen offset:1024 lds
    s_waitcnt vmcnt(4)
    s_mov_b64 exec, 1
    buffer_store_dword v3, off, s[32:35], s70 sc1
    s_mov_b64 exec, -1
    s_waitcnt lgkmcnt(0)
    s_barrier
    s_sub_u32 s72, s72, 57344
    v_lshlrev_b32 v81, 4, v1
    v_lshlrev_b32 v82, 2, v1
    buffer_store_dwordx4 v[16:19], v81, s[32:35], s80 offen sc1
    buffer_store_dwordx4 v[16:19], v81, s[32:35], s80 offen offset:1024 sc1
    buffer_store_dword v16, v82, s[32:35], s81 offen sc1
    s_add_u32 m0, s65, 57344
    s_add_u32 s52, s73, 128
    buffer_load_dwordx4 v4, s[20:23], s52 offen lds
    s_add_u32 m0, s65, 61440
    s_add_u32 s52, s73, 114816
    buffer_load_dwordx4 v4, s[20:23], s52 offen lds
    s_mov_b32 s56, 0x100000
Lpoll_5_s:
    buffer_load_dword v12, v245, s[32:35], s75 offen sc1
    s_waitcnt vmcnt(0)
    v_cmp_ne_u32 vcc, s7, v12
    s_cbranch_vccz Ldone_6_s
    s_sub_u32 s56, s56, 1
    s_cbranch_scc0 Lpoll_5_s
Ldone_6_s:
    buffer_load_dwordx4 v[88:91], v2, s[32:35], s54 offen offset:0 sc1
    buffer_load_dwordx4 v[92:95], v2, s[32:35], s54 offen offset:1024 sc1
    s_add_u32 s54, s54, 4096
    buffer_load_dwordx4 v[96:99], v2, s[32:35], s54 offen offset:0 sc1
    buffer_load_dwordx4 v[100:103], v2, s[32:35], s54 offen offset:1024 sc1
    s_add_u32 s54, s54, 4096
    buffer_load_dwordx4 v[104:107], v2, s[32:35], s54 offen offset:0 sc1
    buffer_load_dwordx4 v[108:111], v2, s[32:35], s54 offen offset:1024 sc1
    s_add_u32 s54, s54, 4096
    buffer_load_dwordx4 v[112:115], v2, s[32:35], s54 offen offset:0 sc1
    buffer_load_dwordx4 v[116:119], v2, s[32:35], s54 offen offset:1024 sc1
    buffer_load_dwordx4 v[120:123], v2, s[32:35], s55 offen offset:0 sc1
    buffer_load_dwordx4 v[124:127], v2, s[32:35], s55 offen offset:1024 sc1
    s_add_u32 s55, s55, 4096
    buffer_load_dwordx4 v[128:131], v2, s[32:35], s55 offen offset:0 sc1
    buffer_load_dwordx4 v[132:135], v2, s[32:35], s55 offen offset:1024 sc1
    s_add_u32 s55, s55, 4096
    ds_read_b64_tr_b16 a[128:129], v8 offset:4096
    ds_read_b64_tr_b16 a[130:131], v8 offset:5120
    ds_read_b64_tr_b16 a[132:133], v9 offset:4096
    ds_read_b64_tr_b16 a[134:135], v9 offset:5120
    ds_read_b64_tr_b16 a[136:137], v8 offset:6144
    ds_read_b64_tr_b16 a[138:139], v8 offset:7168
    ds_read_b64_tr_b16 a[140:141], v9 offset:6144
    ds_read_b64_tr_b16 a[142:143], v9 offset:7168
    ds_read_b64_tr_b16 a[144:145], v8 offset:8192
    ds_read_b64_tr_b16 a[146:147], v8 offset:9216
    ds_read_b64_tr_b16 a[148:149], v9 offset:8192
    ds_read_b64_tr_b16 a[150:151], v9 offset:9216
    s_waitcnt vmcnt(11)
    v_mfma_f32_32x32x16_bf16 v[176:191], a[0:3], v[88:91], v[176:191]
    buffer_load_dwordx4 v[136:139], v2, s[32:35], s55 offen offset:0 sc1
    buffer_load_dwordx4 v[140:143], v2, s[32:35], s55 offen offset:1024 sc1
    s_add_u32 s55, s55, 4096
    v_mfma_f32_32x32x16_bf16 v[192:207], a[4:7], v[88:91], 0
    s_waitcnt vmcnt(12)
    v_mfma_f32_32x32x16_bf16 v[176:191], a[8:11], v[92:95], v[176:191]
    buffer_load_dwordx4 v[144:147], v2, s[32:35], s55 offen offset:0 sc1
    buffer_load_dwordx4 v[148:151], v2, s[32:35], s55 offen offset:1024 sc1
    v_mfma_f32_32x32x16_bf16 v[192:207], a[12:15], v[92:95], v[192:207]
    s_waitcnt vmcnt(13)
    v_mfma_f32_32x32x16_bf16 v[176:191], a[16:19], v[96:99], v[176:191]
    v_mfma_f32_32x32x16_bf16 v[192:207], a[20:23], v[96:99], v[192:207]
    s_waitcnt vmcnt(12)
    v_mfma_f32_32x32x16_bf16 v[176:191], a[24:27], v[100:103], v[176:191]
    v_mfma_f32_32x32x16_bf16 v[192:207], a[28:31], v[100:103], v[192:207]
    s_waitcnt vmcnt(11)
    v_mfma_f32_32x32x16_bf16 v[176:191], a[32:35], v[104:107], v[176:191]
    v_mfma_f32_32x32x16_bf16 v[192:207], a[36:39], v[104:107], v[192:207]
    s_waitcnt vmcnt(10)
    v_mfma_f32_32x32x16_bf16 v[176:191], a[40:43], v[108:111], v[176:191]
    v_mfma_f32_32x32x16_bf16 v[192:207], a[44:47], v[108:111], v[192:207]
    s_waitcnt vmcnt(9)
    v_mfma_f32_32x32x16_bf16 v[176:191], a[48:51], v[112:115], v[176:191]
    v_mfma_f32_32x32x16_bf16 v[192:207], a[52:55], v[112:115], v[192:207]
    s_waitcnt vmcnt(8)
    v_mfma_f32_32x32x16_bf16 v[176:191], a[56:59], v[116:119], v[176:191]
    v_mfma_f32_32x32x16_bf16 v[192:207], a[60:63], v[116:119], v[192:207]
    s_waitcnt vmcnt(7)
    v_mfma_f32_32x32x16_bf16 v[176:191], a[64:67], v[120:123], v[176:191]
    v_lshlrev_b32 v82, 5, v1
    buffer_load_dword v87, v82, s[32:35], s80 offen sc1
    v_mfma_f32_32x32x16_bf16 v[192:207], a[68:71], v[120:123], v[192:207]
    v_lshlrev_b32 v82, 2, v1
    buffer_load_dword v87, v82, s[32:35], s81 offen sc1
    s_waitcnt vmcnt(8)
    v_mfma_f32_32x32x16_bf16 v[176:191], a[72:75], v[124:127], v[176:191]
    v_mfma_f32_32x32x16_bf16 v[192:207], a[76:79], v[124:127], v[192:207]
    s_add_u32 m0, s65, 65536
    s_add_u32 s52, s73, 229504
    buffer_load_dwordx4 v4, s[20:23], s52 offen lds
    s_waitcnt vmcnt(8)
    v_mfma_f32_32x32x16_bf16 v[192:207], a[84:87], v[128:131], v[192:207]
    s_waitcnt vmcnt(7)
    v_mfma_f32_32x32x16_bf16 v[192:207], a[92:95], v[132:135], v[192:207]
    s_add_u32 m0, s65, 69632
    s_add_u32 s52, s73, 344192
    buffer_load_dwordx4 v4, s[20:23], s52 offen lds
    s_waitcnt vmcnt(7)
    v_mfma_f32_32x32x16_bf16 v[192:207], a[100:103], v[136:139], v[192:207]
    s_add_u32 m0, s65, 73728
    s_add_u32 s52, s73, 458880
    buffer_load_dwordx4 v4, s[20:23], s52 offen lds
    s_waitcnt vmcnt(7)
    v_mfma_f32_32x32x16_bf16 v[192:207], a[108:111], v[140:143], v[192:207]
    s_waitcnt vmcnt(6)
    v_mfma_f32_32x32x16_bf16 v[192:207], a[116:119], v[144:147], v[192:207]
    s_add_u32 m0, s65, 77824
    s_add_u32 s52, s73, 573568
    buffer_load_dwordx4 v4, s[20:23], s52 offen lds
    s_waitcnt vmcnt(6)
    v_mfma_f32_32x32x16_bf16 v[192:207], a[124:127], v[148:151], v[192:207]
    v_mfma_f32_32x32x16_bf16 v[176:191], a[80:83], v[128:131], v[176:191]
    v_mfma_f32_32x32x16_bf16 v[176:191], a[88:91], v[132:135], v[176:191]
    v_mfma_f32_32x32x16_bf16 v[176:191], a[96:99], v[136:139], v[176:191]
    s_nop 8
    ds_write_b128 v240, v[192:195] offset:0
    v_mfma_f32_32x32x16_bf16 v[176:191], a[104:107], v[140:143], v[176:191]
    ds_write_b128 v240, v[196:199] offset:1024
    v_mfma_f32_32x32x16_bf16 v[176:191], a[112:115], v[144:147], v[176:191]
    ds_write_b128 v240, v[200:203] offset:2048
    v_mfma_f32_32x32x16_bf16 v[176:191], a[120:123], v[148:151], v[176:191]
    ds_write_b128 v240, v[204:207] offset:3072
    s_waitcnt lgkmcnt(0)
    s_barrier
    ds_read_b128 v[24:27], v243 offset:0
    ds_read_b128 v[28:31], v243 offset:1024
    ds_read_b128 v[32:35], v243 offset:2048
    ds_read_b128 v[36:39], v243 offset:3072
    s_waitcnt lgkmcnt(3)
    s_nop 3
    v_pk_add_f32 v[176:177], v[176:177], v[24:25]
    v_pk_add_f32 v[178:179], v[178:179], v[26:27]
    v_cvt_pk_bf16_f32 v72, v176, v177
    v_cvt_pk_bf16_f32 v73, v178, v179
    s_waitcnt lgkmcnt(2)
    v_pk_add_f32 v[180:181], v[180:181], v[28:29]
    v_pk_add_f32 v[182:183], v[182:183], v[30:31]
    v_cvt_pk_bf16_f32 v74, v180, v181
    v_cvt_pk_bf16_f32 v75, v182, v183
    s_waitcnt lgkmcnt(1)
    v_pk_add_f32 v[184:185], v[184:185], v[32:33]
    v_pk_add_f32 v[186:187], v[186:187], v[34:35]
    v_cvt_pk_bf16_f32 v76, v184, v185
    v_cvt_pk_bf16_f32 v77, v186, v187
    s_waitcnt lgkmcnt(0)
    v_pk_add_f32 v[188:189], v[188:189], v[36:37]
    v_pk_add_f32 v[190:191], v[190:191], v[38:39]
    v_cvt_pk_bf16_f32 v78, v188, v189
    v_cvt_pk_bf16_f32 v79, v190, v191
    buffer_store_dwordx4 v[72:75], v2, s[32:35], s80 offen sc1
    buffer_store_dwordx4 v[76:79], v2, s[32:35], s80 offen offset:1024 sc1
    ds_read_b64_tr_b16 a[0:1], v244 offset:0
    ds_read_b64_tr_b16 a[2:3], v244 offset:1024
    ds_read_b64_tr_b16 a[4:5], v244 offset:2048
    ds_read_b64_tr_b16 a[6:7], v244 offset:3072
    ds_read_b64_tr_b16 a[8:9], v244 offset:4096
    ds_read_b64_tr_b16 a[10:11], v244 offset:5120
    v_dot2_f32_bf16 v80, v72, v246, 0
    v_dot2_f32_bf16 v81, v72, v72, 0
    v_dot2_f32_bf16 v80, v73, v246, v80
    v_dot2_f32_bf16 v81, v73, v73, v81
    v_dot2_f32_bf16 v80, v74, v246, v80
    v_dot2_f32_bf16 v81, v74, v74, v81
    v_dot2_f32_bf16 v80, v75, v246, v80
    v_dot2_f32_bf16 v81, v75, v75, v81
    v_dot2_f32_bf16 v80, v76, v246, v80
    v_dot2_f32_bf16 v81, v76, v76, v81
    v_dot2_f32_bf16 v80, v77, v246, v80
    v_dot2_f32_bf16 v81, v77, v77, v81
    v_dot2_f32_bf16 v80, v78, v246, v80
    v_dot2_f32_bf16 v81, v78, v78, v81
    v_dot2_f32_bf16 v80, v79, v246, v80
    v_dot2_f32_bf16 v81, v79, v79, v81
    v_mov_b32 v86, v247
    ds_read_b64_tr_b16 a[12:13], v244 offset:6144
    ds_read_b64_tr_b16 a[14:15], v244 offset:7168
    v_mov_b32 v82, v80
    v_mov_b32 v83, v81
    ds_read_b64_tr_b16 a[16:17], v244 offset:8192
    ds_read_b64_tr_b16 a[18:19], v244 offset:9216
    v_permlane32_swap_b32 v80, v82
    v_permlane32_swap_b32 v81, v83
    v_pk_add_f32 v[80:81], v[80:81], v[82:83]
    s_mov_b64 exec, s[48:49]
    buffer_store_dwordx2 v[80:81], v6, s[32:35], s81 offen sc1
    s_mov_b64 exec, -1
    ds_read_b64_tr_b16 a[20:21], v244 offset:10240
    ds_read_b64_tr_b16 a[22:23], v244 offset:11264
    v_mov_b32 v28, v244
    v_add_u32 v29, 57344, v244
    s_waitcnt lgkmcnt(10)
    v_mfma_f32_16x16x32_bf16 v[24:27], v[16:19], a[0:3], 0
    ds_read_b64_tr_b16 a[24:25], v28 offset:12288
    ds_read_b64_tr_b16 a[26:27], v28 offset:13312
    v_mov_b32 v240, v72
    v_mov_b32 v241, v73
    s_waitcnt lgkmcnt(10)
    v_mfma_f32_16x16x32_bf16 v[24:27], v[16:19], a[4:7], v[24:27]
    ds_read_b64_tr_b16 a[28:29], v28 offset:14336
    ds_read_b64_tr_b16 a[30:31], v28 offset:15360
    v_mov_b32 v242, v74
    s_add_u32 m0, s65, 81920
    s_add_u32 s52, s73, 688256
    buffer_load_dwordx4 v4, s[20:23], s52 offen lds
    s_waitcnt lgkmcnt(10)
    v_mfma_f32_16x16x32_bf16 v[24:27], v[16:19], a[8:11], v[24:27]
    ds_read_b64_tr_b16 a[0:1], v28 offset:16384
    ds_read_b64_tr_b16 a[2:3], v28 offset:17408
    v_mov_b32 v243, v75
    v_mov_b32 v244, v76
    s_waitcnt lgkmcnt(10)
    v_mfma_f32_16x16x32_bf16 v[24:27], v[16:19], a[12:15], v[24:27]
    ds_read_b64_tr_b16 a[4:5], v28 offset:18432
    ds_read_b64_tr_b16 a[6:7], v28 offset:19456
    s_add_u32 m0, s65, 86016
    s_add_u32 s52, s73, 802944
    buffer_load_dwordx4 v4, s[20:23], s52 offen lds
    v_mov_b32 v245, v77
    s_waitcnt lgkmcnt(10)
    v_mfma_f32_16x16x32_bf16 v[24:27], v[16:19], a[16:19], v[24:27]
    ds_read_b64_tr_b16 a[8:9], v28 offset:20480
    ds_read_b64_tr_b16 a[10:11], v28 offset:21504
    v_mov_b32 v246, v78
    s_add_u32 m0, s65, 90112
    s_add_u32 s52, s73, 917632
    buffer_load_dwordx4 v4, s[20:23], s52 offen lds
    s_waitcnt vmcnt(4)
    s_mov_b64 exec, 1
    buffer_store_dword v3, off, s[32:35], s82 sc1
    s_mov_b64 exec, -1
    s_waitcnt lgkmcnt(10)
    v_mfma_f32_16x16x32_bf16 v[24:27], v[16:19], a[20:23], v[24:27]
    ds_read_b64_tr_b16 a[12:13], v28 offset:22528
    ds_read_b64_tr_b16 a[14:15], v28 offset:23552
    v_mov_b32 v247, v79
    v_and_b32 v30, 15, v1
    s_waitcnt lgkmcnt(10)
    v_mfma_f32_16x16x32_bf16 v[24:27], v[16:19], a[24:27], v[24:27]
    ds_read_b64_tr_b16 a[16:17], v28 offset:24576
    ds_read_b64_tr_b16 a[18:19], v28 offset:25600
    s_add_u32 m0, s65, 94208
    s_add_u32 s52, s73, 1032320
    buffer_load_dwordx4 v4, s[20:23], s52 offen lds
    s_waitcnt lgkmcnt(10)
    v_mfma_f32_16x16x32_bf16 v[24:27], v[16:19], a[28:31], v[24:27]
    ds_read_b64_tr_b16 a[20:21], v28 offset:26624
    ds_read_b64_tr_b16 a[22:23], v28 offset:27648
    v_min_u32 v30, 13, v30
    v_lshlrev_b32 v30, 2, v30
    s_waitcnt lgkmcnt(10)
    v_mfma_f32_16x16x32_bf16 v[24:27], v[16:19], a[0:3], v[24:27]
    s_lshl_b32 s53, s84, 6
    s_add_u32 s53, s53, 24576
    s_add_u32 m0, s65, 98304
    s_add_u32 s52, s73, 1147008
    buffer_load_dwordx4 v4, s[20:23], s52 offen lds
    s_waitcnt lgkmcnt(8)
    v_mfma_f32_16x16x32_bf16 v[24:27], v[16:19], a[4:7], v[24:27]
    s_lshl_b32 s55, s84, 12
    s_add_u32 s55, s55, 131072
    v_lshl_add_u32 v31, v1, 2, s83
    s_waitcnt lgkmcnt(6)
    v_mfma_f32_16x16x32_bf16 v[24:27], v[16:19], a[8:11], v[24:27]
    s_add_u32 m0, s65, 102400
    s_add_u32 s52, s73, 1261696
    buffer_load_dwordx4 v4, s[20:23], s52 offen lds
    v_lshrrev_b32 v32, 5, v1
    s_waitcnt lgkmcnt(4)
    v_mfma_f32_16x16x32_bf16 v[24:27], v[16:19], a[12:15], v[24:27]
    v_mul_u32_u24 v32, 24576, v32
    s_add_u32 m0, s65, 106496
    s_add_u32 s52, s73, 1376384
    buffer_load_dwordx4 v4, s[20:23], s52 offen lds
    s_waitcnt lgkmcnt(2)
    v_mfma_f32_16x16x32_bf16 v[24:27], v[16:19], a[16:19], v[24:27]
    v_lshl_add_u32 v32, v1, 2, v32
    v_add_u32 v32, 124928, v32
    s_waitcnt lgkmcnt(0)
    v_mfma_f32_16x16x32_bf16 v[24:27], v[16:19], a[20:23], v[24:27]
    s_add_u32 m0, s65, 110592
    s_add_u32 s52, s73, 1491072
    buffer_load_dwordx4 v4, s[20:23], s52 offen lds
    s_waitcnt vmcnt(9)
    s_mov_b64 exec, 1
    buffer_store_dword v86, off, s[32:35], s82 sc1
    s_mov_b64 exec, -1
    buffer_load_dword v84, v30, s[32:35], s53 offen sc1
    s_add_u32 m0, s83, 0
    s_nop 0
    buffer_load_dwordx4 v7, s[24:27], s93 offen lds
    buffer_load_dwordx4 v15, s[24:27], s93 offen offset:1024 lds
    s_add_u32 m0, s83, 2048
    s_nop 0
    buffer_load_dwordx4 v7, s[24:27], s94 offen lds
    buffer_load_dwordx4 v15, s[24:27], s94 offen offset:1024 lds
    v_cvt_pk_bf16_f32 v34, v24, v24
    v_and_b32 v34, 0xffff0000, v34
    v_sub_f32 v33, v24, v34
    v_cvt_pk_bf16_f32 v33, v34, v33
    ds_write_b32 v31, v33 offset:10240
    ds_read_b64_tr_b16 a[88:89], v172 offset:0
    ds_read_b64_tr_b16 a[90:91], v172 offset:1024
    ds_read_b64_tr_b16 a[92:93], v173 offset:0
    ds_read_b64_tr_b16 a[94:95], v173 offset:1024
    ds_read_b64_tr_b16 a[96:97], v172 offset:2048
    ds_read_b64_tr_b16 a[98:99], v172 offset:3072
    ds_read_b64_tr_b16 a[100:101], v173 offset:2048
    ds_read_b64_tr_b16 a[102:103], v173 offset:3072
    ds_read_b64_tr_b16 a[104:105], v172 offset:4096
    ds_read_b64_tr_b16 a[106:107], v172 offset:5120
    ds_read_b64_tr_b16 a[108:109], v173 offset:4096
    ds_read_b64_tr_b16 a[110:111], v173 offset:5120
    ds_read_b64_tr_b16 a[112:113], v172 offset:6144
    ds_read_b64_tr_b16 a[114:115], v172 offset:7168
    ds_read_b64_tr_b16 a[116:117], v173 offset:6144
    ds_read_b64_tr_b16 a[118:119], v173 offset:7168
    ds_read_b64_tr_b16 a[120:121], v172 offset:8192
    ds_read_b64_tr_b16 a[122:123], v172 offset:9216
    ds_read_b64_tr_b16 a[124:125], v173 offset:8192
    ds_read_b64_tr_b16 a[126:127], v173 offset:9216
    s_waitcnt vmcnt(4)
    v_and_b32 v85, -8, v84
    v_cmp_ne_u32 vcc, s7, v85
    s_cbranch_vccz Ldone_8_s
    s_mov_b32 s56, 0x100000
Lpoll_7_s:
    buffer_load_dword v84, v30, s[32:35], s53 offen sc1
    s_waitcnt vmcnt(0)
    v_and_b32 v85, -8, v84
    v_cmp_ne_u32 vcc, s7, v85
    s_cbranch_vccz Ldone_8_s
    s_sub_u32 s56, s56, 1
    s_cbranch_scc0 Lpoll_7_s
Ldone_8_s:
    buffer_load_dwordx4 v[40:43], v2, s[32:35], s85 offen offset:0 sc1
    buffer_load_dwordx4 v[44:47], v2, s[32:35], s85 offen offset:1024 sc1
    buffer_load_dwordx4 v[48:51], v2, s[32:35], s85 offen offset:2048 sc1
    buffer_load_dwordx4 v[52:55], v2, s[32:35], s85 offen offset:3072 sc1
    s_add_u32 s85, s85, 4096
    buffer_load_dwordx4 v[56:59], v2, s[32:35], s85 offen offset:0 sc1
    buffer_load_dwordx4 v[60:63], v2, s[32:35], s85 offen offset:1024 sc1
    buffer_load_dwordx4 v[64:67], v2, s[32:35], s85 offen offset:2048 sc1
    buffer_load_dwordx4 v[68:71], v2, s[32:35], s85 offen offset:3072 sc1
    s_add_u32 s85, s85, 4096
    buffer_load_dword v12, v30, s[32:35], s53 offen sc1
    s_waitcnt lgkmcnt(15)
    s_barrier
    ds_read_b32 v152, v32 offset:0
    ds_read_b32 v156, v32 offset:12288
    ds_read_b64_tr_b16 a[24:25], v29 offset:0
    ds_read_b64_tr_b16 a[26:27], v29 offset:1024
    ds_read_b64_tr_b16 a[28:29], v29 offset:2048
    ds_read_b64_tr_b16 a[30:31], v29 offset:3072
    ds_read_b64_tr_b16 a[0:1], v29 offset:4096
    ds_read_b64_tr_b16 a[2:3], v29 offset:5120
    ds_read_b64_tr_b16 a[4:5], v29 offset:6144
    ds_read_b64_tr_b16 a[6:7], v29 offset:7168
    ds_read_b64_tr_b16 a[8:9], v29 offset:8192
    ds_read_b64_tr_b16 a[10:11], v29 offset:9216
    ds_read_b64_tr_b16 a[12:13], v29 offset:10240
    ds_read_b64_tr_b16 a[14:15], v29 offset:11264
    s_waitcnt lgkmcnt(10)
    v_mfma_f32_16x16x32_bf16 v[24:27], v[16:19], a[24:27], 0
    ds_read_b64_tr_b16 a[16:17], v29 offset:12288
    ds_read_b64_tr_b16 a[18:19], v29 offset:13312
    s_waitcnt lgkmcnt(10)
    v_mfma_f32_16x16x32_bf16 v[24:27], v[16:19], a[28:31], v[24:27]
    ds_read_b64_tr_b16 a[20:21], v29 offset:14336
    ds_read_b64_tr_b16 a[22:23], v29 offset:15360
    s_waitcnt lgkmcnt(10)
    v_mfma_f32_16x16x32_bf16 v[24:27], v[16:19], a[0:3], v[24:27]
    ds_read_b64_tr_b16 a[24:25], v29 offset:16384
    ds_read_b64_tr_b16 a[26:27], v29 offset:17408
    s_waitcnt lgkmcnt(10)
    v_mfma_f32_16x16x32_bf16 v[24:27], v[16:19], a[4:7], v[24:27]
    ds_read_b64_tr_b16 a[28:29], v29 offset:18432
    ds_read_b64_tr_b16 a[30:31], v29 offset:19456
    s_waitcnt lgkmcnt(10)
    v_mfma_f32_16x16x32_bf16 v[24:27], v[16:19], a[8:11], v[24:27]
    ds_read_b64_tr_b16 a[0:1], v29 offset:20480
    ds_read_b64_tr_b16 a[2:3], v29 offset:21504
    s_waitcnt lgkmcnt(10)
    v_mfma_f32_16x16x32_bf16 v[24:27], v[16:19], a[12:15], v[24:27]
    ds_read_b64_tr_b16 a[4:5], v29 offset:22528
    ds_read_b64_tr_b16 a[6:7], v29 offset:23552
    s_waitcnt lgkmcnt(10)
    v_mfma_f32_16x16x32_bf16 v[24:27], v[16:19], a[16:19], v[24:27]
    ds_read_b64_tr_b16 a[8:9], v29 offset:24576
    ds_read_b64_tr_b16 a[10:11], v29 offset:25600
    s_waitcnt lgkmcnt(10)
    v_mfma_f32_16x16x32_bf16 v[24:27], v[16:19], a[20:23], v[24:27]
    ds_read_b64_tr_b16 a[12:13], v29 offset:26624
    ds_read_b64_tr_b16 a[14:15], v29 offset:27648
    s_waitcnt lgkmcnt(10)
    v_mfma_f32_16x16x32_bf16 v[24:27], v[16:19], a[24:27], v[24:27]
    s_waitcnt vmcnt(11)
    ds_read_b64_tr_b16 a[152:153], v8 offset:0
    ds_read_b64_tr_b16 a[154:155], v8 offset:1024
    s_waitcnt lgkmcnt(10)
    v_mfma_f32_16x16x32_bf16 v[24:27], v[16:19], a[28:31], v[24:27]
    ds_read_b64_tr_b16 a[156:157], v9 offset:0
    ds_read_b64_tr_b16 a[158:159], v9 offset:1024
    s_waitcnt lgkmcnt(10)
    v_mfma_f32_16x16x32_bf16 v[24:27], v[16:19], a[0:3], v[24:27]
    s_waitcnt vmcnt(9)
    ds_read_b64_tr_b16 a[160:161], v8 offset:2048
    ds_read_b64_tr_b16 a[162:163], v8 offset:3072
    s_waitcnt lgkmcnt(10)
    v_mfma_f32_16x16x32_bf16 v[24:27], v[16:19], a[4:7], v[24:27]
    ds_read_b64_tr_b16 a[164:165], v9 offset:2048
    ds_read_b64_tr_b16 a[166:167], v9 offset:3072
    s_waitcnt lgkmcnt(10)
    v_mfma_f32_16x16x32_bf16 v[24:27], v[16:19], a[8:11], v[24:27]
    s_waitcnt lgkmcnt(8)
    v_mfma_f32_16x16x32_bf16 v[24:27], v[16:19], a[12:15], v[24:27]
    s_waitcnt vmcnt(8)
    v_mfma_f32_32x32x16_bf16 v[208:223], a[88:91], v[40:43], 0
    ds_read_b64_tr_b16 a[240:241], v172 offset:10240
    ds_read_b64_tr_b16 a[242:243], v172 offset:11264
    ds_read_b64_tr_b16 a[244:245], v173 offset:10240
    ds_read_b64_tr_b16 a[246:247], v173 offset:11264
    v_mfma_f32_32x32x16_bf16 v[224:239], a[92:95], v[40:43], 0
    buffer_load_dwordx4 v[72:75], v2, s[32:35], s85 offen offset:0 sc1
    ds_read_b64_tr_b16 a[248:249], v172 offset:12288
    ds_read_b64_tr_b16 a[250:251], v172 offset:13312
    s_waitcnt vmcnt(8)
    v_mfma_f32_32x32x16_bf16 v[208:223], a[96:99], v[44:47], v[208:223]
    ds_read_b64_tr_b16 a[252:253], v173 offset:12288
    ds_read_b64_tr_b16 a[254:255], v173 offset:13312
    v_mfma_f32_32x32x16_bf16 v[224:239], a[100:103], v[44:47], v[224:239]
    buffer_load_dwordx4 v[76:79], v2, s[32:35], s85 offen offset:1024 sc1
    ds_read_b64_tr_b16 a[88:89], v172 offset:14336
    ds_read_b64_tr_b16 a[90:91], v172 offset:15360
    s_waitcnt vmcnt(8)
    v_mfma_f32_32x32x16_bf16 v[208:223], a[104:107], v[48:51], v[208:223]
    ds_read_b64_tr_b16 a[92:93], v173 offset:14336
    ds_read_b64_tr_b16 a[94:95], v173 offset:15360
    v_mfma_f32_32x32x16_bf16 v[224:239], a[108:111], v[48:51], v[224:239]
    buffer_load_dwordx4 v[80:83], v2, s[32:35], s85 offen offset:2048 sc1
    ds_read_b64_tr_b16 a[96:97], v172 offset:16384
    ds_read_b64_tr_b16 a[98:99], v172 offset:17408
    s_waitcnt vmcnt(8)
    v_mfma_f32_32x32x16_bf16 v[208:223], a[112:115], v[52:55], v[208:223]
    ds_read_b64_tr_b16 a[100:101], v173 offset:16384
    ds_read_b64_tr_b16 a[102:103], v173 offset:17408
    v_mfma_f32_32x32x16_bf16 v[224:239], a[116:119], v[52:55], v[224:239]
    buffer_load_dwordx4 v[84:87], v2, s[32:35], s85 offen offset:3072 sc1
    s_add_u32 s85, s85, 4096
    ds_read_b64_tr_b16 a[104:105], v172 offset:18432
    ds_read_b64_tr_b16 a[106:107], v172 offset:19456
    s_waitcnt vmcnt(8)
    v_mfma_f32_32x32x16_bf16 v[208:223], a[120:123], v[56:59], v[208:223]
    ds_read_b64_tr_b16 a[108:109], v173 offset:18432
    ds_read_b64_tr_b16 a[110:111], v173 offset:19456
    v_mfma_f32_32x32x16_bf16 v[224:239], a[124:127], v[56:59], v[224:239]
    buffer_load_dwordx4 v[88:91], v2, s[32:35], s85 offen offset:0 sc1
    ds_read_b64_tr_b16 a[112:113], v172 offset:20480
    ds_read_b64_tr_b16 a[114:115], v172 offset:21504
    s_waitcnt vmcnt(8) lgkmcnt(15)
    v_mfma_f32_32x32x16_bf16 v[208:223], a[240:243], v[60:63], v[208:223]
    s_waitcnt vmcnt(5)
    v_cmp_ne_u32 vcc, s60, v12
    s_cbranch_vccz Ldone_10_s
    s_mov_b32 s56, 0x100000
Lpoll_9_s:
    buffer_load_dword v12, v30, s[32:35], s53 offen sc1
    s_waitcnt vmcnt(0)
    v_cmp_ne_u32 vcc, s60, v12
    s_cbranch_vccz Ldone_10_s
    s_sub_u32 s56, s56, 1
    s_cbranch_scc0 Lpoll_9_s
Ldone_10_s:
    buffer_load_dwordx2 v[194:195], v6, s[32:35], s55 offen offset:0 sc1
    v_mfma_f32_32x32x16_bf16 v[224:239], a[244:247], v[60:63], v[224:239]
    buffer_load_dwordx4 v[92:95], v2, s[32:35], s85 offen offset:1024 sc1
    v_cvt_pk_bf16_f32 v34, v24, v24
    v_and_b32 v34, 0xffff0000, v34
    s_waitcnt lgkmcnt(14)
    v_mfma_f32_32x32x16_bf16 v[208:223], a[248:251], v[64:67], v[208:223]
    buffer_load_dwordx2 v[196:197], v6, s[32:35], s55 offen offset:512 sc1
    v_sub_f32 v33, v24, v34
    v_cvt_pk_bf16_f32 v33, v34, v33
    ds_write_b32 v31, v33 offset:10496
    v_mfma_f32_32x32x16_bf16 v[224:239], a[252:255], v[64:67], v[224:239]
    buffer_load_dwordx4 v[96:99], v2, s[32:35], s85 offen offset:2048 sc1
    ds_read_b64_tr_b16 a[116:117], v173 offset:20480
    ds_read_b64_tr_b16 a[118:119], v173 offset:21504
    s_waitcnt lgkmcnt(13)
    v_mfma_f32_32x32x16_bf16 v[208:223], a[88:91], v[68:71], v[208:223]
    buffer_load_dwordx2 v[198:199], v6, s[32:35], s55 offen offset:1024 sc1
    ds_read_b64_tr_b16 a[120:121], v172 offset:22528
    ds_read_b64_tr_b16 a[122:123], v172 offset:23552
    v_mfma_f32_32x32x16_bf16 v[224:239], a[92:95], v[68:71], v[224:239]
    buffer_load_dwordx4 v[100:103], v2, s[32:35], s85 offen offset:3072 sc1
    s_add_u32 s85, s85, 4096
    ds_read_b64_tr_b16 a[124:125], v173 offset:22528
    ds_read_b64_tr_b16 a[126:127], v173 offset:23552
    s_waitcnt vmcnt(10) lgkmcnt(13)
    v_mfma_f32_32x32x16_bf16 v[208:223], a[96:99], v[72:75], v[208:223]
    buffer_load_dwordx2 v[200:201], v6, s[32:35], s55 offen offset:1536 sc1
    ds_read_b64_tr_b16 a[240:241], v172 offset:24576
    ds_read_b64_tr_b16 a[242:243], v172 offset:25600
    v_mfma_f32_32x32x16_bf16 v[224:239], a[100:103], v[72:75], v[224:239]
    buffer_load_dwordx4 v[104:107], v2, s[32:35], s85 offen offset:0 sc1
    ds_read_b64_tr_b16 a[244:245], v173 offset:24576
    ds_read_b64_tr_b16 a[246:247], v173 offset:25600
    s_waitcnt vmcnt(11) lgkmcnt(13)
    v_mfma_f32_32x32x16_bf16 v[208:223], a[104:107], v[76:79], v[208:223]
    buffer_load_dwordx2 v[202:203], v6, s[32:35], s55 offen offset:2048 sc1
    ds_read_b64_tr_b16 a[248:249], v172 offset:26624
    ds_read_b64_tr_b16 a[250:251], v172 offset:27648
    v_mfma_f32_32x32x16_bf16 v[224:239], a[108:111], v[76:79], v[224:239]
    buffer_load_dwordx4 v[108:111], v2, s[32:35], s85 offen offset:1024 sc1
    ds_read_b64_tr_b16 a[252:253], v173 offset:26624
    ds_read_b64_tr_b16 a[254:255], v173 offset:27648
    s_waitcnt vmcnt(12) lgkmcnt(12)
    v_mfma_f32_32x32x16_bf16 v[208:223], a[112:115], v[80:83], v[208:223]
    buffer_load_dwordx2 v[204:205], v6, s[32:35], s55 offen offset:2560 sc1
    ds_read_b64_tr_b16 a[88:89], v172 offset:28672
    ds_read_b64_tr_b16 a[90:91], v172 offset:29696
    v_mfma_f32_32x32x16_bf16 v[224:239], a[116:119], v[80:83], v[224:239]
    buffer_load_dwordx4 v[112:115], v2, s[32:35], s85 offen offset:2048 sc1
    ds_read_b64_tr_b16 a[92:93], v173 offset:28672
    ds_read_b64_tr_b16 a[94:95], v173 offset:29696
    s_waitcnt vmcnt(13) lgkmcnt(12)
    v_mfma_f32_32x32x16_bf16 v[208:223], a[120:123], v[84:87], v[208:223]
    buffer_load_dwordx2 v[206:207], v6, s[32:35], s55 offen offset:3072 sc1
    ds_read_b64_tr_b16 a[96:97], v172 offset:30720
    ds_read_b64_tr_b16 a[98:99], v172 offset:31744
    v_mfma_f32_32x32x16_bf16 v[224:239], a[124:127], v[84:87], v[224:239]
    buffer_load_dwordx4 v[116:119], v2, s[32:35], s85 offen offset:3072 sc1
    s_add_u32 s85, s85, 4096
    ds_read_b64_tr_b16 a[100:101], v173 offset:30720
    ds_read_b64_tr_b16 a[102:103], v173 offset:31744
    s_waitcnt vmcnt(14) lgkmcnt(12)
    v_mfma_f32_32x32x16_bf16 v[208:223], a[240:243], v[88:91], v[208:223]
    ds_read_b64_tr_b16 a[104:105], v172 offset:32768
    ds_read_b64_tr_b16 a[106:107], v172 offset:33792
    ds_read_b64_tr_b16 a[108:109], v173 offset:32768
    ds_read_b64_tr_b16 a[110:111], v173 offset:33792
    ds_read_b64_tr_b16 a[112:113], v172 offset:34816
    ds_read_b64_tr_b16 a[114:115], v172 offset:35840
    v_mfma_f32_32x32x16_bf16 v[224:239], a[244:247], v[88:91], v[224:239]
    buffer_load_dwordx4 v[120:123], v2, s[32:35], s85 offen offset:0 sc1
    ds_read_b64_tr_b16 a[116:117], v173 offset:34816
    ds_read_b64_tr_b16 a[118:119], v173 offset:35840
    s_waitcnt vmcnt(13) lgkmcnt(15)
    v_mfma_f32_32x32x16_bf16 v[208:223], a[248:251], v[92:95], v[208:223]
    ds_read_b64_tr_b16 a[120:121], v172 offset:36864
    ds_read_b64_tr_b16 a[122:123], v172 offset:37888
    ds_read_b64_tr_b16 a[124:125], v173 offset:36864
    ds_read_b64_tr_b16 a[126:127], v173 offset:37888
    v_mfma_f32_32x32x16_bf16 v[224:239], a[252:255], v[92:95], v[224:239]
    buffer_load_dwordx4 v[124:127], v2, s[32:35], s85 offen offset:1024 sc1
    ds_read_b64_tr_b16 a[240:241], v172 offset:38912
    ds_read_b64_tr_b16 a[242:243], v172 offset:39936
    s_waitcnt vmcnt(12) lgkmcnt(15)
    v_mfma_f32_32x32x16_bf16 v[208:223], a[88:91], v[96:99], v[208:223]
    ds_read_b64_tr_b16 a[244:245], v173 offset:38912
    ds_read_b64_tr_b16 a[246:247], v173 offset:39936
    v_mfma_f32_32x32x16_bf16 v[224:239], a[92:95], v[96:99], v[224:239]
    buffer_load_dwordx4 v[128:131], v2, s[32:35], s85 offen offset:2048 sc1
    ds_read_b64_tr_b16 a[248:249], v172 offset:40960
    ds_read_b64_tr_b16 a[250:251], v172 offset:41984
    s_waitcnt vmcnt(11) lgkmcnt(15)
    v_mfma_f32_32x32x16_bf16 v[208:223], a[96:99], v[100:103], v[208:223]
    ds_read_b64_tr_b16 a[252:253], v173 offset:40960
    ds_read_b64_tr_b16 a[254:255], v173 offset:41984
    v_mfma_f32_32x32x16_bf16 v[224:239], a[100:103], v[100:103], v[224:239]
    buffer_load_dwordx4 v[132:135], v2, s[32:35], s85 offen offset:3072 sc1
    s_add_u32 s85, s85, 4096
    ds_read_b64_tr_b16 a[88:89], v172 offset:43008
    ds_read_b64_tr_b16 a[90:91], v172 offset:44032
    s_waitcnt vmcnt(10) lgkmcnt(15)
    v_mfma_f32_32x32x16_bf16 v[208:223], a[104:107], v[104:107], v[208:223]
    ds_read_b64_tr_b16 a[92:93], v173 offset:43008
    ds_read_b64_tr_b16 a[94:95], v173 offset:44032
    v_mfma_f32_32x32x16_bf16 v[224:239], a[108:111], v[104:107], v[224:239]
    buffer_load_dwordx4 v[136:139], v2, s[32:35], s85 offen offset:0 sc1
    ds_read_b64_tr_b16 a[96:97], v172 offset:45056
    ds_read_b64_tr_b16 a[98:99], v172 offset:46080
    s_waitcnt vmcnt(9) lgkmcnt(15)
    v_mfma_f32_32x32x16_bf16 v[208:223], a[112:115], v[108:111], v[208:223]
    v_add_f32 v194, v194, v196
    v_add_f32 v195, v195, v197
    v_add_f32 v194, v194, v198
    v_add_f32 v195, v195, v199
    v_add_f32 v194, v194, v200
    v_add_f32 v195, v195, v201
    v_mfma_f32_32x32x16_bf16 v[224:239], a[116:119], v[108:111], v[224:239]
    buffer_load_dwordx4 v[140:143], v2, s[32:35], s85 offen offset:1024 sc1
    v_add_f32 v194, v194, v202
    v_add_f32 v195, v195, v203
    s_waitcnt vmcnt(8) lgkmcnt(14)
    v_mfma_f32_32x32x16_bf16 v[208:223], a[120:123], v[112:115], v[208:223]
    v_add_f32 v194, v194, v204
    v_add_f32 v195, v195, v205
    s_waitcnt vmcnt(7)
    v_add_f32 v194, v194, v206
    v_add_f32 v195, v195, v207
    v_mov_b32 v196, v194
    v_mov_b32 v197, v195
    v_mfma_f32_32x32x16_bf16 v[224:239], a[124:127], v[112:115], v[224:239]
    buffer_load_dwordx4 v[144:147], v2, s[32:35], s85 offen offset:2048 sc1
    v_permlane32_swap_b32 v194, v196
    v_permlane32_swap_b32 v195, v197
    s_waitcnt vmcnt(7) lgkmcnt(10)
    v_mfma_f32_32x32x16_bf16 v[208:223], a[240:243], v[116:119], v[208:223]
    v_add_f32 v194, v194, v196
    v_add_f32 v195, v195, v197
    v_mul_f32 v196, 0x3b124925, v194
    v_mul_f32 v198, 0x3b124925, v195
    v_fma_f32 v198, -v196, v196, v198
    v_max_f32 v198, 0, v198
    v_mfma_f32_32x32x16_bf16 v[224:239], a[244:247], v[116:119], v[224:239]
    buffer_load_dwordx4 v[148:151], v2, s[32:35], s85 offen offset:3072 sc1
    s_add_u32 s85, s85, 4096
    v_cvt_pk_bf16_f32 v198, v198, v198
    v_and_b32 v198, 0xffff0000, v198
    s_waitcnt vmcnt(7) lgkmcnt(6)
    v_mfma_f32_32x32x16_bf16 v[208:223], a[248:251], v[120:123], v[208:223]
    ds_read_b64_tr_b16 a[100:101], v173 offset:45056
    ds_read_b64_tr_b16 a[102:103], v173 offset:46080
    v_add_f32 v198, 0x3727c5ac, v198
    v_cvt_pk_bf16_f32 v198, v198, v198
    v_and_b32 v198, 0xffff0000, v198
    v_mfma_f32_32x32x16_bf16 v[224:239], a[252:255], v[120:123], v[224:239]
    ds_read_b64_tr_b16 a[104:105], v172 offset:47104
    ds_read_b64_tr_b16 a[106:107], v172 offset:48128
    v_sqrt_f32 v198, v198
    s_nop 0
    v_cvt_pk_bf16_f32 v198, v198, v198
    v_and_b32 v197, 0xffff0000, v198
    s_waitcnt vmcnt(6) lgkmcnt(6)
    v_mfma_f32_32x32x16_bf16 v[208:223], a[88:91], v[124:127], v[208:223]
    ds_read_b64_tr_b16 a[108:109], v173 offset:47104
    ds_read_b64_tr_b16 a[110:111], v173 offset:48128
    v_rcp_f32 v199, v197
    v_cvt_pk_bf16_f32 v168, -v196, -v196
    v_lshrrev_b32 v197, 16, v197
    v_mfma_f32_32x32x16_bf16 v[224:239], a[92:95], v[124:127], v[224:239]
    ds_read_b64_tr_b16 a[112:113], v172 offset:49152
    ds_read_b64_tr_b16 a[114:115], v172 offset:50176
    v_cndmask_b32_e64 v169, 0, v197, s[48:49]
    v_mul_f32 v199, v199, v199
    ds_write_b32 v31, v199 offset:10752
    s_waitcnt vmcnt(5) lgkmcnt(7)
    v_mfma_f32_32x32x16_bf16 v[208:223], a[96:99], v[128:131], v[208:223]
    ds_read_b64_tr_b16 a[116:117], v173 offset:49152
    ds_read_b64_tr_b16 a[118:119], v173 offset:50176
    ds_read_b64_tr_b16 a[120:121], v172 offset:51200
    ds_read_b64_tr_b16 a[122:123], v172 offset:52224
    ds_read_b64_tr_b16 a[124:125], v173 offset:51200
    ds_read_b64_tr_b16 a[126:127], v173 offset:52224
    v_mfma_f32_32x32x16_bf16 v[224:239], a[100:103], v[128:131], v[224:239]
    s_add_u32 m0, s83, 4096
    s_nop 0
    buffer_load_dwordx4 v7, s[24:27], s95 offen lds
    ds_read_b64_tr_b16 a[240:241], v172 offset:53248
    ds_read_b64_tr_b16 a[242:243], v172 offset:54272
    s_waitcnt vmcnt(5) lgkmcnt(11)
    v_mfma_f32_32x32x16_bf16 v[208:223], a[104:107], v[132:135], v[208:223]
    buffer_load_dwordx4 v15, s[24:27], s95 offen offset:1024 lds
    ds_read_b64_tr_b16 a[244:245], v173 offset:53248
    ds_read_b64_tr_b16 a[246:247], v173 offset:54272
    v_mfma_f32_32x32x16_bf16 v[224:239], a[108:111], v[132:135], v[224:239]
    s_add_u32 m0, s83, 6144
    s_nop 0
    buffer_load_dwordx4 v7, s[24:27], s96 offen lds
    ds_read_b64_tr_b16 a[248:249], v172 offset:55296
    ds_read_b64_tr_b16 a[250:251], v172 offset:56320
    s_waitcnt vmcnt(6) lgkmcnt(10)
    v_mfma_f32_32x32x16_bf16 v[208:223], a[112:115], v[136:139], v[208:223]
    buffer_load_dwordx4 v15, s[24:27], s96 offen offset:1024 lds
    ds_read_b64_tr_b16 a[252:253], v173 offset:55296
    ds_read_b64_tr_b16 a[254:255], v173 offset:56320
    v_mfma_f32_32x32x16_bf16 v[224:239], a[116:119], v[136:139], v[224:239]
    s_add_u32 m0, s83, 8192
    v_add_u32 v7, 28672, v7
    v_add_u32 v15, 6144, v7
    buffer_load_dwordx4 v7, s[24:27], s90 offen lds
    ds_read_b64_tr_b16 a[88:89], v174 offset:0
    ds_read_b64_tr_b16 a[90:91], v174 offset:1024
    s_waitcnt vmcnt(7) lgkmcnt(10)
    v_mfma_f32_32x32x16_bf16 v[208:223], a[120:123], v[140:143], v[208:223]
    buffer_load_dwordx4 v15, s[24:27], s90 offen offset:1024 lds
    ds_read_b64_tr_b16 a[92:93], v174 offset:2048
    ds_read_b64_tr_b16 a[94:95], v174 offset:3072
    ds_read_b64_tr_b16 a[96:97], v174 offset:4096
    ds_read_b64_tr_b16 a[98:99], v174 offset:5120
    v_mfma_f32_32x32x16_bf16 v[224:239], a[124:127], v[140:143], v[224:239]
    s_add_u32 m0, s83, 0
    s_nop 0
    buffer_load_dwordx4 v7, s[24:27], s91 offen lds
    ds_read_b64_tr_b16 a[100:101], v174 offset:6144
    ds_read_b64_tr_b16 a[102:103], v174 offset:7168
    ds_read_b64_tr_b16 a[104:105], v174 offset:8192
    ds_read_b64_tr_b16 a[106:107], v174 offset:9216
    s_waitcnt vmcnt(8) lgkmcnt(14)
    v_mfma_f32_32x32x16_bf16 v[208:223], a[240:243], v[144:147], v[208:223]
    buffer_load_dwordx4 v15, s[24:27], s91 offen offset:1024 lds
    ds_read_b64_tr_b16 a[108:109], v174 offset:10240
    ds_read_b64_tr_b16 a[110:111], v174 offset:11264
    ds_read_b64_tr_b16 a[112:113], v174 offset:12288
    ds_read_b64_tr_b16 a[114:115], v174 offset:13312
    v_mfma_f32_32x32x16_bf16 v[224:239], a[244:247], v[144:147], v[224:239]
    s_add_u32 m0, s83, 2048
    s_nop 0
    buffer_load_dwordx4 v7, s[24:27], s92 offen lds
    ds_read_b64_tr_b16 a[116:117], v174 offset:14336
    ds_read_b64_tr_b16 a[118:119], v174 offset:15360
    ds_read_b64_tr_b16 a[120:121], v174 offset:16384
    ds_read_b64_tr_b16 a[122:123], v174 offset:17408
    s_waitcnt vmcnt(9) lgkmcnt(15)
    v_mfma_f32_32x32x16_bf16 v[208:223], a[248:251], v[148:151], v[208:223]
    v_mfma_f32_32x32x16_bf16 v[208:223], v[152:155], v[168:171], v[208:223]
    s_barrier
    ds_read_b32 v160, v32 offset:256
    ds_read_b32 v164, v32 offset:12544
    buffer_load_dwordx4 v15, s[24:27], s92 offen offset:1024 lds
    v_mfma_f32_32x32x16_bf16 v[224:239], a[252:255], v[148:151], v[224:239]
    v_mfma_f32_32x32x16_bf16 v[224:239], v[156:159], v[168:171], v[224:239]
    s_add_u32 m0, s72, 0
    s_nop 0
    buffer_load_dwordx4 v7, s[24:27], s93 offen lds
    ds_read_b64_tr_b16 a[124:125], v174 offset:18432
    ds_read_b64_tr_b16 a[126:127], v174 offset:19456
    ds_read_b64_tr_b16 a[240:241], v174 offset:20480
    ds_read_b64_tr_b16 a[242:243], v174 offset:21504
    s_waitcnt lgkmcnt(15)
    v_mfma_f32_32x32x16_bf16 v[176:191], a[88:91], v[40:43], 0
    buffer_load_dwordx4 v15, s[24:27], s93 offen offset:1024 lds
    ds_read_b64_tr_b16 a[244:245], v174 offset:22528
    ds_read_b64_tr_b16 a[246:247], v174 offset:23552
    v_mfma_f32_32x32x16_bf16 v[176:191], a[92:95], v[44:47], v[176:191]
    v_mul_f32_e64 v208, v208, |v208|
    v_mul_f32_e64 v209, v209, |v209|
    v_cvt_pk_bf16_f32 v208, v208, v209
    v_pk_max_i16 v208, v208, 0
    v_mul_f32_e64 v210, v210, |v210|
    v_mul_f32_e64 v211, v211, |v211|
    v_cvt_pk_bf16_f32 v209, v210, v211
    v_pk_max_i16 v209, v209, 0
    v_mul_f32_e64 v212, v212, |v212|
    v_mul_f32_e64 v213, v213, |v213|
    v_cvt_pk_bf16_f32 v210, v212, v213
    v_pk_max_i16 v210, v210, 0
    v_mul_f32_e64 v214, v214, |v214|
    v_mul_f32_e64 v215, v215, |v215|
    v_cvt_pk_bf16_f32 v211, v214, v215
    v_pk_max_i16 v211, v211, 0
    v_mul_f32_e64 v216, v216, |v216|
    v_mul_f32_e64 v217, v217, |v217|
    v_cvt_pk_bf16_f32 v212, v216, v217
    v_pk_max_i16 v212, v212, 0
    v_mul_f32_e64 v218, v218, |v218|
    v_mul_f32_e64 v219, v219, |v219|
    v_cvt_pk_bf16_f32 v213, v218, v219
    v_pk_max_i16 v213, v213, 0
    v_mul_f32_e64 v220, v220, |v220|
    v_mul_f32_e64 v221, v221, |v221|
    v_mfma_f32_32x32x16_bf16 v[176:191], a[96:99], v[48:51], v[176:191]
    v_cvt_pk_bf16_f32 v214, v220, v221
    v_pk_max_i16 v214, v214, 0
    v_mul_f32_e64 v222, v222, |v222|
    v_mul_f32_e64 v223, v223, |v223|
    v_cvt_pk_bf16_f32 v215, v222, v223
    v_pk_max_i16 v215, v215, 0
    ds_read_b64_tr_b16 a[248:249], v174 offset:24576
    ds_read_b64_tr_b16 a[250:251], v174 offset:25600
    v_mfma_f32_32x32x16_bf16 v[176:191], a[100:103], v[52:55], v[176:191]
    s_add_u32 s54, s87, 0
    buffer_store_dwordx4 v[208:211], v2, s[32:35], s54 offen offset:0 sc1
    buffer_store_dwordx4 v[212:215], v2, s[32:35], s54 offen offset:1024 sc1
    s_waitcnt lgkmcnt(15)
    v_mfma_f32_32x32x16_bf16 v[176:191], a[104:107], v[56:59], v[176:191]
    v_mul_f32_e64 v224, v224, |v224|
    v_mul_f32_e64 v225, v225, |v225|
    v_cvt_pk_bf16_f32 v224, v224, v225
    v_pk_max_i16 v224, v224, 0
    v_mul_f32_e64 v226, v226, |v226|
    v_mul_f32_e64 v227, v227, |v227|
    v_cvt_pk_bf16_f32 v225, v226, v227
    v_pk_max_i16 v225, v225, 0
    v_mfma_f32_32x32x16_bf16 v[176:191], a[108:111], v[60:63], v[176:191]
    v_mul_f32_e64 v228, v228, |v228|
    v_mul_f32_e64 v229, v229, |v229|
    v_cvt_pk_bf16_f32 v226, v228, v229
    v_pk_max_i16 v226, v226, 0
    v_mul_f32_e64 v230, v230, |v230|
    v_mul_f32_e64 v231, v231, |v231|
    v_cvt_pk_bf16_f32 v227, v230, v231
    v_pk_max_i16 v227, v227, 0
    s_waitcnt lgkmcnt(12)
    v_mfma_f32_32x32x16_bf16 v[176:191], a[112:115], v[64:67], v[176:191]
    v_mul_f32_e64 v232, v232, |v232|
    v_mul_f32_e64 v233, v233, |v233|
    v_cvt_pk_bf16_f32 v228, v232, v233
    v_pk_max_i16 v228, v228, 0
    v_mul_f32_e64 v234, v234, |v234|
    v_mul_f32_e64 v235, v235, |v235|
    v_cvt_pk_bf16_f32 v229, v234, v235
    v_pk_max_i16 v229, v229, 0
    v_mfma_f32_32x32x16_bf16 v[176:191], a[116:119], v[68:71], v[176:191]
    v_mul_f32_e64 v236, v236, |v236|
    v_mul_f32_e64 v237, v237, |v237|
    v_cvt_pk_bf16_f32 v230, v236, v237
    v_pk_max_i16 v230, v230, 0
    v_mul_f32_e64 v238, v238, |v238|
    v_mul_f32_e64 v239, v239, |v239|
    v_cvt_pk_bf16_f32 v231, v238, v239
    v_pk_max_i16 v231, v231, 0
    s_waitcnt lgkmcnt(6)
    v_mfma_f32_32x32x16_bf16 v[176:191], a[120:123], v[72:75], v[176:191]
    ds_read_b64_tr_b16 a[252:253], v174 offset:26624
    ds_read_b64_tr_b16 a[254:255], v174 offset:27648
    s_add_u32 m0, s72, 2048
    s_nop 0
    buffer_load_dwordx4 v7, s[24:27], s94 offen lds
    v_mfma_f32_32x32x16_bf16 v[176:191], a[124:127], v[76:79], v[176:191]
    ds_read_b64_tr_b16 a[88:89], v174 offset:28672
    ds_read_b64_tr_b16 a[90:91], v174 offset:29696
    buffer_load_dwordx4 v15, s[24:27], s94 offen offset:1024 lds
    ds_read_b64_tr_b16 a[92:93], v174 offset:30720
    ds_read_b64_tr_b16 a[94:95], v174 offset:31744
    s_waitcnt lgkmcnt(8)
    v_mfma_f32_32x32x16_bf16 v[176:191], a[240:243], v[80:83], v[176:191]
    s_add_u32 m0, s72, 4096
    s_nop 0
    buffer_load_dwordx4 v7, s[24:27], s95 offen lds
    ds_read_b64_tr_b16 a[96:97], v174 offset:32768
    ds_read_b64_tr_b16 a[98:99], v174 offset:33792
    ds_read_b64_tr_b16 a[100:101], v174 offset:34816
    ds_read_b64_tr_b16 a[102:103], v174 offset:35840
    v_mfma_f32_32x32x16_bf16 v[176:191], a[244:247], v[84:87], v[176:191]
    buffer_load_dwordx4 v15, s[24:27], s95 offen offset:1024 lds
    ds_read_b64_tr_b16 a[104:105], v174 offset:36864
    ds_read_b64_tr_b16 a[106:107], v174 offset:37888
    ds_read_b64_tr_b16 a[108:109], v174 offset:38912
    ds_read_b64_tr_b16 a[110:111], v174 offset:39936
    s_waitcnt lgkmcnt(12)
    v_mfma_f32_32x32x16_bf16 v[176:191], a[248:251], v[88:91], v[176:191]
    s_add_u32 m0, s72, 6144
    s_nop 0
    buffer_load_dwordx4 v7, s[24:27], s96 offen lds
    ds_read_b64_tr_b16 a[112:113], v174 offset:40960
    ds_read_b64_tr_b16 a[114:115], v174 offset:41984
    ds_read_b64_tr_b16 a[116:117], v174 offset:43008
    ds_read_b64_tr_b16 a[118:119], v174 offset:44032
    v_mfma_f32_32x32x16_bf16 v[176:191], a[252:255], v[92:95], v[176:191]
    buffer_load_dwordx4 v15, s[24:27], s96 offen offset:1024 lds
    ds_read_b64_tr_b16 a[120:121], v174 offset:45056
    ds_read_b64_tr_b16 a[122:123], v174 offset:46080
    ds_read_b64_tr_b16 a[124:125], v174 offset:47104
    ds_read_b64_tr_b16 a[126:127], v174 offset:48128
    s_waitcnt lgkmcnt(15)
    v_mfma_f32_32x32x16_bf16 v[176:191], a[88:91], v[96:99], v[176:191]
    s_add_u32 s54, s87, 28672
    buffer_store_dwordx4 v[224:227], v2, s[32:35], s54 offen offset:0 sc1
    buffer_store_dwordx4 v[228:231], v2, s[32:35], s54 offen offset:1024 sc1
    v_mfma_f32_32x32x16_bf16 v[176:191], a[92:95], v[100:103], v[176:191]
    s_add_u32 m0, s72, 8192
    v_add_u32 v7, 28672, v7
    v_add_u32 v15, 6144, v7
    buffer_load_dwordx4 v7, s[24:27], s90 offen lds
    ds_read_b64_tr_b16 a[240:241], v174 offset:49152
    ds_read_b64_tr_b16 a[242:243], v174 offset:50176
    ds_read_b64_tr_b16 a[244:245], v174 offset:51200
    ds_read_b64_tr_b16 a[246:247], v174 offset:52224
    s_waitcnt lgkmcnt(15)
    v_mfma_f32_32x32x16_bf16 v[176:191], a[96:99], v[104:107], v[176:191]
    buffer_load_dwordx4 v15, s[24:27], s90 offen offset:1024 lds
    ds_read_b64_tr_b16 a[248:249], v174 offset:53248
    ds_read_b64_tr_b16 a[250:251], v174 offset:54272
    ds_read_b64_tr_b16 a[252:253], v174 offset:55296
    ds_read_b64_tr_b16 a[254:255], v174 offset:56320
    v_mfma_f32_32x32x16_bf16 v[176:191], a[100:103], v[108:111], v[176:191]
    s_add_u32 m0, s72, 10240
    s_nop 0
    buffer_load_dwordx4 v7, s[24:27], s91 offen lds
    ds_read_b64_tr_b16 a[88:89], v175 offset:0
    ds_read_b64_tr_b16 a[90:91], v175 offset:1024
    s_waitcnt lgkmcnt(15)
    v_mfma_f32_32x32x16_bf16 v[176:191], a[104:107], v[112:115], v[176:191]
    buffer_load_dwordx4 v15, s[24:27], s91 offen offset:1024 lds
    ds_read_b64_tr_b16 a[92:93], v175 offset:2048
    ds_read_b64_tr_b16 a[94:95], v175 offset:3072
    v_mfma_f32_32x32x16_bf16 v[176:191], a[108:111], v[116:119], v[176:191]
    s_add_u32 m0, s72, 12288
    s_nop 0
    buffer_load_dwordx4 v7, s[24:27], s92 offen lds
    ds_read_b64_tr_b16 a[96:97], v175 offset:4096
    ds_read_b64_tr_b16 a[98:99], v175 offset:5120
    s_waitcnt lgkmcnt(15)
    v_mfma_f32_32x32x16_bf16 v[176:191], a[112:115], v[120:123], v[176:191]
    buffer_load_dwordx4 v15, s[24:27], s92 offen offset:1024 lds
    s_waitcnt vmcnt(26)
    ds_read_b64_tr_b16 a[168:169], v8 offset:4096
    ds_read_b64_tr_b16 a[170:171], v8 offset:5120
    ds_read_b64_tr_b16 a[172:173], v9 offset:4096
    ds_read_b64_tr_b16 a[174:175], v9 offset:5120
    v_mfma_f32_32x32x16_bf16 v[176:191], a[116:119], v[124:127], v[176:191]
    ds_read_b64_tr_b16 a[100:101], v175 offset:6144
    ds_read_b64_tr_b16 a[102:103], v175 offset:7168
    ds_read_b64_tr_b16 a[104:105], v175 offset:8192
    ds_read_b64_tr_b16 a[106:107], v175 offset:9216
    s_waitcnt lgkmcnt(15)
    v_mfma_f32_32x32x16_bf16 v[176:191], a[120:123], v[128:131], v[176:191]
    s_waitcnt vmcnt(24)
    ds_read_b64_tr_b16 a[176:177], v8 offset:6144
    ds_read_b64_tr_b16 a[178:179], v8 offset:7168
    ds_read_b64_tr_b16 a[180:181], v9 offset:6144
    ds_read_b64_tr_b16 a[182:183], v9 offset:7168
    v_mfma_f32_32x32x16_bf16 v[176:191], a[124:127], v[132:135], v[176:191]
    s_waitcnt lgkmcnt(8)
    s_add_u32 m0, s83, 4096
    s_nop 0
    buffer_load_dwordx4 v7, s[24:27], s93 offen lds
    ds_read_b64_tr_b16 a[108:109], v175 offset:10240
    ds_read_b64_tr_b16 a[110:111], v175 offset:11264
    ds_read_b64_tr_b16 a[112:113], v175 offset:12288
    ds_read_b64_tr_b16 a[114:115], v175 offset:13312
    v_mfma_f32_32x32x16_bf16 v[176:191], a[240:243], v[136:139], v[176:191]
    buffer_load_dwordx4 v15, s[24:27], s93 offen offset:1024 lds
    s_waitcnt vmcnt(24)
    ds_read_b64_tr_b16 a[184:185], v8 offset:8192
    ds_read_b64_tr_b16 a[186:187], v8 offset:9216
    ds_read_b64_tr_b16 a[188:189], v9 offset:8192
    ds_read_b64_tr_b16 a[190:191], v9 offset:9216
    v_mfma_f32_32x32x16_bf16 v[176:191], a[244:247], v[140:143], v[176:191]
    ds_read_b64_tr_b16 a[116:117], v175 offset:14336
    ds_read_b64_tr_b16 a[118:119], v175 offset:15360
    ds_read_b64_tr_b16 a[120:121], v175 offset:16384
    ds_read_b64_tr_b16 a[122:123], v175 offset:17408
    v_mfma_f32_32x32x16_bf16 v[176:191], a[248:251], v[144:147], v[176:191]
    s_waitcnt vmcnt(8)
    s_mov_b64 exec, 1
    buffer_store_dword v3, off, s[32:35], s88 sc1
    s_mov_b64 exec, -1
    v_mfma_f32_32x32x16_bf16 v[176:191], a[252:255], v[148:151], v[176:191]
    v_mfma_f32_32x32x16_bf16 v[176:191], v[160:163], v[168:171], v[176:191]
    ds_read_b64_tr_b16 a[192:193], v8 offset:0
    ds_read_b64_tr_b16 a[194:195], v8 offset:1024
    ds_read_b64_tr_b16 a[196:197], v9 offset:0
    ds_read_b64_tr_b16 a[198:199], v9 offset:1024
    v_mfma_f32_32x32x16_bf16 v[192:207], a[88:91], v[40:43], 0
    s_waitcnt lgkmcnt(15)
    s_add_u32 m0, s83, 6144
    s_nop 0
    buffer_load_dwordx4 v7, s[24:27], s94 offen lds
    ds_read_b64_tr_b16 a[200:201], v8 offset:2048
    ds_read_b64_tr_b16 a[202:203], v8 offset:3072
    v_mfma_f32_32x32x16_bf16 v[192:207], a[92:95], v[44:47], v[192:207]
    buffer_load_dwordx4 v15, s[24:27], s94 offen offset:1024 lds
    ds_read_b64_tr_b16 a[204:205], v9 offset:2048
    ds_read_b64_tr_b16 a[206:207], v9 offset:3072
    ds_read_b64_tr_b16 a[124:125], v175 offset:18432
    ds_read_b64_tr_b16 a[126:127], v175 offset:19456
    v_mfma_f32_32x32x16_bf16 v[192:207], a[96:99], v[48:51], v[192:207]
    v_mul_f32_e64 v176, v176, |v176|
    v_mul_f32_e64 v177, v177, |v177|
    v_cvt_pk_bf16_f32 v176, v176, v177
    v_pk_max_i16 v176, v176, 0
    v_mul_f32_e64 v178, v178, |v178|
    v_mul_f32_e64 v179, v179, |v179|
    v_cvt_pk_bf16_f32 v177, v178, v179
    v_pk_max_i16 v177, v177, 0
    v_mfma_f32_32x32x16_bf16 v[192:207], a[100:103], v[52:55], v[192:207]
    v_mul_f32_e64 v180, v180, |v180|
    v_mul_f32_e64 v181, v181, |v181|
    v_cvt_pk_bf16_f32 v178, v180, v181
    v_pk_max_i16 v178, v178, 0
    v_mul_f32_e64 v182, v182, |v182|
    v_mul_f32_e64 v183, v183, |v183|
    v_cvt_pk_bf16_f32 v179, v182, v183
    v_pk_max_i16 v179, v179, 0
    s_waitcnt lgkmcnt(15)
    v_mfma_f32_32x32x16_bf16 v[192:207], a[104:107], v[56:59], v[192:207]
    s_nop 0
    v_mul_f32_e64 v184, v184, |v184|
    v_mul_f32_e64 v185, v185, |v185|
    v_cvt_pk_bf16_f32 v180, v184, v185
    v_pk_max_i16 v180, v180, 0
    v_mul_f32_e64 v186, v186, |v186|
    v_mul_f32_e64 v187, v187, |v187|
    v_cvt_pk_bf16_f32 v181, v186, v187
    v_mfma_f32_32x32x16_bf16 v[192:207], a[108:111], v[60:63], v[192:207]
    ds_read_b64_tr_b16 a[240:241], v175 offset:20480
    ds_read_b64_tr_b16 a[242:243], v175 offset:21504
    v_pk_max_i16 v181, v181, 0
    v_mul_f32_e64 v188, v188, |v188|
    v_mul_f32_e64 v189, v189, |v189|
    v_cvt_pk_bf16_f32 v182, v188, v189
    v_pk_max_i16 v182, v182, 0
    v_mul_f32_e64 v190, v190, |v190|
    s_waitcnt lgkmcnt(14)
    v_mfma_f32_32x32x16_bf16 v[192:207], a[112:115], v[64:67], v[192:207]
    ds_read_b64_tr_b16 a[244:245], v175 offset:22528
    ds_read_b64_tr_b16 a[246:247], v175 offset:23552
    buffer_load_dword v12, v10, s[32:35], s89 offen sc1
    v_add_u32 v37, s76, v2
    v_add_u32 v38, s77, v2
    v_mfma_f32_32x32x16_bf16 v[192:207], a[116:119], v[68:71], v[192:207]
    ds_read_b64_tr_b16 a[248:249], v175 offset:24576
    ds_read_b64_tr_b16 a[250:251], v175 offset:25600
    v_mul_f32_e64 v191, v191, |v191|
    v_cvt_pk_bf16_f32 v183, v190, v191
    v_pk_max_i16 v183, v183, 0
    s_waitcnt lgkmcnt(6)
    v_mfma_f32_32x32x16_bf16 v[192:207], a[120:123], v[72:75], v[192:207]
    ds_read_b64_tr_b16 a[252:253], v175 offset:26624
    ds_read_b64_tr_b16 a[254:255], v175 offset:27648
    ds_read_b64_tr_b16 a[208:209], v5 offset:0
    ds_read_b64_tr_b16 a[210:211], v5 offset:1024
    v_mfma_f32_32x32x16_bf16 v[192:207], a[124:127], v[76:79], v[192:207]
    ds_read_b64_tr_b16 a[88:89], v175 offset:28672
    ds_read_b64_tr_b16 a[90:91], v175 offset:29696
    s_add_u32 m0, s83, 8192
    s_nop 0
    buffer_load_dwordx4 v7, s[24:27], s95 offen lds
    s_waitcnt lgkmcnt(8)
    v_mfma_f32_32x32x16_bf16 v[192:207], a[240:243], v[80:83], v[192:207]
    ds_read_b64_tr_b16 a[92:93], v175 offset:30720
    ds_read_b64_tr_b16 a[94:95], v175 offset:31744
    s_add_u32 s54, s87, 57344
    buffer_store_dwordx4 v[176:179], v2, s[32:35], s54 offen offset:0 sc1
    buffer_store_dwordx4 v[180:183], v2, s[32:35], s54 offen offset:1024 sc1
    v_mfma_f32_32x32x16_bf16 v[192:207], a[244:247], v[84:87], v[192:207]
    ds_read_b64_tr_b16 a[96:97], v175 offset:32768
    ds_read_b64_tr_b16 a[98:99], v175 offset:33792
    buffer_load_dwordx4 v15, s[24:27], s95 offen offset:1024 lds
    ds_read_b64_tr_b16 a[212:213], v14 offset:0
    ds_read_b64_tr_b16 a[214:215], v14 offset:1024
    s_waitcnt lgkmcnt(10)
    v_mfma_f32_32x32x16_bf16 v[192:207], a[248:251], v[88:91], v[192:207]
    ds_read_b64_tr_b16 a[100:101], v175 offset:34816
    ds_read_b64_tr_b16 a[102:103], v175 offset:35840
    ds_read_b64_tr_b16 a[216:217], v5 offset:2048
    ds_read_b64_tr_b16 a[218:219], v5 offset:3072
    v_mfma_f32_32x32x16_bf16 v[192:207], a[252:255], v[92:95], v[192:207]
    ds_read_b64_tr_b16 a[104:105], v175 offset:36864
    ds_read_b64_tr_b16 a[106:107], v175 offset:37888
    ds_read_b64_tr_b16 a[220:221], v14 offset:2048
    ds_read_b64_tr_b16 a[222:223], v14 offset:3072
    ds_read_b64_tr_b16 a[108:109], v175 offset:38912
    ds_read_b64_tr_b16 a[110:111], v175 offset:39936
    s_waitcnt lgkmcnt(14)
    v_mfma_f32_32x32x16_bf16 v[192:207], a[88:91], v[96:99], v[192:207]
    s_add_u32 m0, s83, 0
    s_nop 0
    buffer_load_dwordx4 v7, s[24:27], s96 offen lds
    ds_read_b64_tr_b16 a[224:225], v5 offset:4096
    ds_read_b64_tr_b16 a[226:227], v5 offset:5120
    v_mfma_f32_32x32x16_bf16 v[192:207], a[92:95], v[100:103], v[192:207]
    ds_read_b64_tr_b16 a[112:113], v175 offset:40960
    ds_read_b64_tr_b16 a[114:115], v175 offset:41984
    buffer_load_dwordx4 v15, s[24:27], s96 offen offset:1024 lds
    ds_read_b64_tr_b16 a[228:229], v14 offset:4096
    ds_read_b64_tr_b16 a[230:231], v14 offset:5120
    s_waitcnt lgkmcnt(14)
    v_mfma_f32_32x32x16_bf16 v[192:207], a[96:99], v[104:107], v[192:207]
    ds_read_b64_tr_b16 a[116:117], v175 offset:43008
    ds_read_b64_tr_b16 a[118:119], v175 offset:44032
    s_waitcnt vmcnt(6)
    v_cmp_ne_u32 vcc, s7, v12
    s_cbranch_vccz Ldone_12_s
    s_mov_b32 s56, 0x100000
Lpoll_11_s:
    buffer_load_dword v12, v10, s[32:35], s89 offen sc1
    s_waitcnt vmcnt(0)
    v_cmp_ne_u32 vcc, s7, v12
    s_cbranch_vccz Ldone_12_s
    s_sub_u32 s56, s56, 1
    s_cbranch_scc0 Lpoll_11_s
Ldone_12_s:
    buffer_load_dwordx4 a[32:35], v38, s[32:35], s36 offen sc1
    buffer_load_dwordx4 a[36:39], v38, s[32:35], s37 offen sc1
    v_mfma_f32_32x32x16_bf16 v[192:207], a[100:103], v[108:111], v[192:207]
    ds_read_b64_tr_b16 a[120:121], v175 offset:45056
    ds_read_b64_tr_b16 a[122:123], v175 offset:46080
    buffer_load_dwordx4 a[40:43], v38, s[32:35], s38 offen sc1
    ds_read_b64_tr_b16 a[124:125], v175 offset:47104
    ds_read_b64_tr_b16 a[126:127], v175 offset:48128
    s_waitcnt lgkmcnt(12)
    v_mfma_f32_32x32x16_bf16 v[192:207], a[104:107], v[112:115], v[192:207]
    buffer_load_dwordx4 a[44:47], v38, s[32:35], s39 offen sc1
    buffer_load_dwordx4 a[48:51], v38, s[32:35], s40 offen sc1
    v_mfma_f32_32x32x16_bf16 v[192:207], a[108:111], v[116:119], v[192:207]
    ds_read_b64_tr_b16 a[240:241], v175 offset:49152
    ds_read_b64_tr_b16 a[242:243], v175 offset:50176
    buffer_load_dwordx4 a[52:55], v38, s[32:35], s41 offen sc1
    ds_read_b64_tr_b16 a[244:245], v175 offset:51200
    ds_read_b64_tr_b16 a[246:247], v175 offset:52224
    s_waitcnt lgkmcnt(8)
    v_mfma_f32_32x32x16_bf16 v[192:207], a[112:115], v[120:123], v[192:207]
    s_add_u32 s53, s53, 4096
    buffer_load_dword v36, v30, s[32:35], s53 offen sc1
    buffer_load_dwordx4 a[56:59], v38, s[32:35], s42 offen sc1
    v_mfma_f32_32x32x16_bf16 v[192:207], a[116:119], v[124:127], v[192:207]
    ds_read_b64_tr_b16 a[248:249], v175 offset:53248
    ds_read_b64_tr_b16 a[250:251], v175 offset:54272
    buffer_load_dwordx4 a[60:63], v37, s[32:35], s36 offen sc1
    ds_read_b64_tr_b16 a[252:253], v175 offset:55296
    ds_read_b64_tr_b16 a[254:255], v175 offset:56320
    s_waitcnt lgkmcnt(8)
    v_mfma_f32_32x32x16_bf16 v[192:207], a[120:123], v[128:131], v[192:207]
    buffer_load_dwordx4 a[64:67], v37, s[32:35], s37 offen sc1
    buffer_load_dwordx4 a[68:71], v37, s[32:35], s38 offen sc1
    v_mfma_f32_32x32x16_bf16 v[192:207], a[124:127], v[132:135], v[192:207]
    buffer_load_dwordx4 a[72:75], v37, s[32:35], s39 offen sc1
    s_waitcnt lgkmcnt(4)
    v_mfma_f32_32x32x16_bf16 v[192:207], a[240:243], v[136:139], v[192:207]
    buffer_load_dwordx4 a[76:79], v37, s[32:35], s40 offen sc1
    ds_read_b64_tr_b16 a[232:233], v5 offset:6144
    ds_read_b64_tr_b16 a[234:235], v5 offset:7168
    v_mfma_f32_32x32x16_bf16 v[192:207], a[244:247], v[140:143], v[192:207]
    buffer_load_dwordx4 a[80:83], v37, s[32:35], s41 offen sc1
    s_add_u32 m0, s83, 2048
    v_add_u32 v7, 28672, v7
    v_add_u32 v15, 6144, v7
    buffer_load_dwordx4 v7, s[24:27], s90 offen lds
    s_waitcnt lgkmcnt(2)
    v_mfma_f32_32x32x16_bf16 v[192:207], a[248:251], v[144:147], v[192:207]
    buffer_load_dwordx4 a[84:87], v37, s[32:35], s42 offen sc1
    buffer_load_dwordx4 v15, s[24:27], s90 offen offset:1024 lds
    v_mfma_f32_32x32x16_bf16 v[192:207], a[252:255], v[148:151], v[192:207]
    v_mfma_f32_32x32x16_bf16 v[192:207], v[164:167], v[168:171], v[192:207]
    ds_read_b64_tr_b16 a[236:237], v14 offset:6144
    ds_read_b64_tr_b16 a[238:239], v14 offset:7168
    v_mov_b32 v39, v30
    s_waitcnt vmcnt(16)
    v_mfma_f32_32x32x16_bf16 v[208:223], a[128:131], a[32:35], 0
    v_add_u32 v25, 28672, v37
    v_add_u32 v26, 57344, v37
    v_add_u32 v27, 86016, v37
    v_add_u32 v29, 28672, v38
    v_mfma_f32_32x32x16_bf16 v[224:239], a[132:135], a[32:35], 0
    v_add_u32 v30, 57344, v38
    v_add_u32 v31, 86016, v38
    s_add_u32 m0, s72, 0
    s_nop 0
    buffer_load_dwordx4 v7, s[24:27], s91 offen lds
    buffer_load_dwordx4 v15, s[24:27], s91 offen offset:1024 lds
    s_waitcnt vmcnt(17)
    v_mfma_f32_32x32x16_bf16 v[208:223], a[136:139], a[36:39], v[208:223]
    v_mul_f32_e64 v192, v192, |v192|
    v_mul_f32_e64 v193, v193, |v193|
    v_cvt_pk_bf16_f32 v192, v192, v193
    v_pk_max_i16 v192, v192, 0
    v_mul_f32_e64 v194, v194, |v194|
    v_mul_f32_e64 v195, v195, |v195|
    v_cvt_pk_bf16_f32 v193, v194, v195
    v_mfma_f32_32x32x16_bf16 v[224:239], a[140:143], a[36:39], v[224:239]
    v_pk_max_i16 v193, v193, 0
    v_mul_f32_e64 v196, v196, |v196|
    v_mul_f32_e64 v197, v197, |v197|
    v_cvt_pk_bf16_f32 v194, v196, v197
    v_pk_max_i16 v194, v194, 0
    s_waitcnt vmcnt(16)
    v_mfma_f32_32x32x16_bf16 v[208:223], a[144:147], a[40:43], v[208:223]
    v_mul_f32_e64 v198, v198, |v198|
    v_mul_f32_e64 v199, v199, |v199|
    v_cvt_pk_bf16_f32 v195, v198, v199
    v_pk_max_i16 v195, v195, 0
    v_mul_f32_e64 v200, v200, |v200|
    v_mul_f32_e64 v201, v201, |v201|
    v_cvt_pk_bf16_f32 v196, v200, v201
    v_mfma_f32_32x32x16_bf16 v[224:239], a[148:151], a[40:43], v[224:239]
    v_pk_max_i16 v196, v196, 0
    v_mul_f32_e64 v202, v202, |v202|
    v_mul_f32_e64 v203, v203, |v203|
    v_cvt_pk_bf16_f32 v197, v202, v203
    s_add_u32 m0, s72, 2048
    s_nop 0
    buffer_load_dwordx4 v7, s[24:27], s92 offen lds
    buffer_load_dwordx4 v15, s[24:27], s92 offen offset:1024 lds
    s_waitcnt vmcnt(17)
    v_mfma_f32_32x32x16_bf16 v[208:223], a[152:155], a[44:47], v[208:223]
    v_pk_max_i16 v197, v197, 0
    v_mul_f32_e64 v204, v204, |v204|
    v_mul_f32_e64 v205, v205, |v205|
    v_cvt_pk_bf16_f32 v198, v204, v205
    v_pk_max_i16 v198, v198, 0
    v_mul_f32_e64 v206, v206, |v206|
    v_mfma_f32_32x32x16_bf16 v[224:239], a[156:159], a[44:47], v[224:239]
    v_mul_f32_e64 v207, v207, |v207|
    v_cvt_pk_bf16_f32 v199, v206, v207
    v_pk_max_i16 v199, v199, 0
    s_waitcnt vmcnt(14)
    v_cmp_ne_u32 vcc, s7, v36
    s_cbranch_vccz Ldone_14_s
    s_mov_b32 s56, 0x100000
Lpoll_13_s:
    buffer_load_dword v36, v39, s[32:35], s53 offen sc1
    s_waitcnt vmcnt(0)
    v_cmp_ne_u32 vcc, s7, v36
    s_cbranch_vccz Ldone_14_s
    s_sub_u32 s56, s56, 1
    s_cbranch_scc0 Lpoll_13_s
Ldone_14_s:
    s_add_u32 s54, s87, 86016
    buffer_store_dwordx4 v[192:195], v2, s[32:35], s54 offen offset:0 sc1
    buffer_store_dwordx4 v[196:199], v2, s[32:35], s54 offen offset:1024 sc1
    s_add_u32 m0, s72, 4096
    s_nop 0
    buffer_load_dwordx4 v7, s[24:27], s93 offen lds
    v_mfma_f32_32x32x16_bf16 v[208:223], a[160:163], a[48:51], v[208:223]
    buffer_load_dwordx4 v15, s[24:27], s93 offen offset:1024 lds
    v_mfma_f32_32x32x16_bf16 v[224:239], a[164:167], a[48:51], v[224:239]
    v_mfma_f32_32x32x16_bf16 v[208:223], a[168:171], a[52:55], v[208:223]
    s_waitcnt lgkmcnt(0)
    s_add_u32 m0, s72, 6144
    s_nop 0
    buffer_load_dwordx4 v7, s[24:27], s94 offen lds
    v_mfma_f32_32x32x16_bf16 v[224:239], a[172:175], a[52:55], v[224:239]
    buffer_load_dwordx4 v15, s[24:27], s94 offen offset:1024 lds
    s_waitcnt vmcnt(19)
    v_mfma_f32_32x32x16_bf16 v[208:223], a[176:179], a[56:59], v[208:223]
    v_mfma_f32_32x32x16_bf16 v[224:239], a[180:183], a[56:59], v[224:239]
    s_waitcnt vmcnt(18)
    v_mfma_f32_32x32x16_bf16 v[176:191], a[128:131], a[60:63], 0
    v_mfma_f32_32x32x16_bf16 v[192:207], a[132:135], a[60:63], 0
    s_waitcnt vmcnt(17)
    v_mfma_f32_32x32x16_bf16 v[176:191], a[136:139], a[64:67], v[176:191]
    buffer_load_dwordx4 v[80:83], v29, s[32:35], s36 offen sc1
    v_mfma_f32_32x32x16_bf16 v[192:207], a[140:143], a[64:67], v[192:207]
    s_add_u32 s88, s88, 4096
    s_waitcnt vmcnt(5)
    s_mov_b64 exec, 1
    buffer_store_dword v3, off, s[32:35], s88 sc1
    s_mov_b64 exec, -1
    v_mfma_f32_32x32x16_bf16 v[176:191], a[144:147], a[68:71], v[176:191]
    buffer_load_dwordx4 v[84:87], v29, s[32:35], s37 offen sc1
    v_mfma_f32_32x32x16_bf16 v[192:207], a[148:151], a[68:71], v[192:207]
    v_mfma_f32_32x32x16_bf16 v[176:191], a[152:155], a[72:75], v[176:191]
    buffer_load_dwordx4 v[88:91], v29, s[32:35], s38 offen sc1
    v_mfma_f32_32x32x16_bf16 v[192:207], a[156:159], a[72:75], v[192:207]
    v_mfma_f32_32x32x16_bf16 v[176:191], a[160:163], a[76:79], v[176:191]
    buffer_load_dwordx4 v[92:95], v29, s[32:35], s39 offen sc1
    v_mfma_f32_32x32x16_bf16 v[192:207], a[164:167], a[76:79], v[192:207]
    v_mfma_f32_32x32x16_bf16 v[176:191], a[168:171], a[80:83], v[176:191]
    buffer_load_dwordx4 v[96:99], v29, s[32:35], s40 offen sc1
    v_mfma_f32_32x32x16_bf16 v[192:207], a[172:175], a[80:83], v[192:207]
    v_mfma_f32_32x32x16_bf16 v[176:191], a[176:179], a[84:87], v[176:191]
    buffer_load_dwordx4 v[100:103], v29, s[32:35], s41 offen sc1
    v_mfma_f32_32x32x16_bf16 v[192:207], a[180:183], a[84:87], v[192:207]
    s_waitcnt vmcnt(6)
    v_mfma_f32_32x32x16_bf16 v[208:223], a[184:187], v[80:83], v[208:223]
    buffer_load_dwordx4 v[104:107], v29, s[32:35], s42 offen sc1
    v_mfma_f32_32x32x16_bf16 v[224:239], a[188:191], v[80:83], v[224:239]
    s_waitcnt vmcnt(5)
    v_mfma_f32_32x32x16_bf16 v[208:223], a[192:195], v[84:87], v[208:223]
    buffer_load_dwordx4 v[108:111], v25, s[32:35], s36 offen sc1
    v_mfma_f32_32x32x16_bf16 v[224:239], a[196:199], v[84:87], v[224:239]
    ds_read_b64_tr_b16 a[0:1], v5 offset:8192
    ds_read_b64_tr_b16 a[2:3], v5 offset:9216
    ds_read_b64_tr_b16 a[4:5], v14 offset:8192
    ds_read_b64_tr_b16 a[6:7], v14 offset:9216
    s_waitcnt lgkmcnt(0)
    s_add_u32 m0, s72, 8192
    s_nop 0
    buffer_load_dwordx4 v7, s[24:27], s95 offen lds
    s_waitcnt vmcnt(6)
    v_mfma_f32_32x32x16_bf16 v[208:223], a[200:203], v[88:91], v[208:223]
    buffer_load_dwordx4 v[112:115], v25, s[32:35], s37 offen sc1
    s_add_u32 s89, s89, 4096
    buffer_load_dword v12, v10, s[32:35], s89 offen sc1
    v_mfma_f32_32x32x16_bf16 v[224:239], a[204:207], v[88:91], v[224:239]
    buffer_load_dwordx4 v15, s[24:27], s95 offen offset:1024 lds
    s_waitcnt vmcnt(8)
    v_mfma_f32_32x32x16_bf16 v[208:223], a[208:211], v[92:95], v[208:223]
    buffer_load_dwordx4 v[116:119], v25, s[32:35], s38 offen sc1
    v_mfma_f32_32x32x16_bf16 v[224:239], a[212:215], v[92:95], v[224:239]
    ds_read_b64_tr_b16 a[8:9], v5 offset:10240
    ds_read_b64_tr_b16 a[10:11], v5 offset:11264
    ds_read_b64_tr_b16 a[12:13], v14 offset:10240
    ds_read_b64_tr_b16 a[14:15], v14 offset:11264
    s_waitcnt lgkmcnt(0)
    s_add_u32 m0, s72, 10240
    s_nop 0
    buffer_load_dwordx4 v7, s[24:27], s96 offen lds
    s_waitcnt vmcnt(9)
    v_mfma_f32_32x32x16_bf16 v[208:223], a[216:219], v[96:99], v[208:223]
    buffer_load_dwordx4 v[72:75], v25, s[32:35], s39 offen sc1
    v_mfma_f32_32x32x16_bf16 v[224:239], a[220:223], v[96:99], v[224:239]
    buffer_load_dwordx4 v15, s[24:27], s96 offen offset:1024 lds
    s_waitcnt vmcnt(10)
    v_mfma_f32_32x32x16_bf16 v[208:223], a[224:227], v[100:103], v[208:223]
    buffer_load_dwordx4 v[76:79], v25, s[32:35], s40 offen sc1
    v_mfma_f32_32x32x16_bf16 v[224:239], a[228:231], v[100:103], v[224:239]
    s_waitcnt vmcnt(10)
    v_mfma_f32_32x32x16_bf16 v[208:223], a[232:235], v[104:107], v[208:223]
    buffer_load_dwordx4 v[80:83], v25, s[32:35], s41 offen sc1
    v_mfma_f32_32x32x16_bf16 v[224:239], a[236:239], v[104:107], v[224:239]
    s_barrier
    ds_read_b32 v168, v13
    s_waitcnt vmcnt(10)
    v_mfma_f32_32x32x16_bf16 v[176:191], a[184:187], v[108:111], v[176:191]
    buffer_load_dwordx4 v[84:87], v25, s[32:35], s42 offen sc1
    v_mfma_f32_32x32x16_bf16 v[192:207], a[188:191], v[108:111], v[192:207]
    s_waitcnt vmcnt(9)
    v_mfma_f32_32x32x16_bf16 v[176:191], a[192:195], v[112:115], v[176:191]
    s_waitcnt vmcnt(8)
    v_cmp_ne_u32 vcc, s7, v12
    s_cbranch_vccz Ldone_16_s
    s_mov_b32 s56, 0x100000
Lpoll_15_s:
    buffer_load_dword v12, v10, s[32:35], s89 offen sc1
    s_waitcnt vmcnt(0)
    v_cmp_ne_u32 vcc, s7, v12
    s_cbranch_vccz Ldone_16_s
    s_sub_u32 s56, s56, 1
    s_cbranch_scc0 Lpoll_15_s
Ldone_16_s:
    buffer_load_dwordx4 v[88:91], v30, s[32:35], s36 offen sc1
    v_mfma_f32_32x32x16_bf16 v[192:207], a[196:199], v[112:115], v[192:207]
    s_waitcnt vmcnt(7)
    v_mfma_f32_32x32x16_bf16 v[176:191], a[200:203], v[116:119], v[176:191]
    buffer_load_dwordx4 v[92:95], v30, s[32:35], s37 offen sc1
    ds_read_b64_tr_b16 a[16:17], v5 offset:12288
    ds_read_b64_tr_b16 a[18:19], v5 offset:13312
    v_mfma_f32_32x32x16_bf16 v[192:207], a[204:207], v[116:119], v[192:207]
    ds_read_b64_tr_b16 a[20:21], v14 offset:12288
    ds_read_b64_tr_b16 a[22:23], v14 offset:13312
    s_waitcnt vmcnt(6)
    v_mfma_f32_32x32x16_bf16 v[176:191], a[208:211], v[72:75], v[176:191]
    buffer_load_dwordx4 v[96:99], v30, s[32:35], s38 offen sc1
    ds_read_b64_tr_b16 a[24:25], v8 offset:4096
    ds_read_b64_tr_b16 a[26:27], v8 offset:5120
    v_mfma_f32_32x32x16_bf16 v[192:207], a[212:215], v[72:75], v[192:207]
    ds_read_b64_tr_b16 a[28:29], v9 offset:4096
    ds_read_b64_tr_b16 a[30:31], v9 offset:5120
    s_waitcnt vmcnt(5)
    v_mfma_f32_32x32x16_bf16 v[176:191], a[216:219], v[76:79], v[176:191]
    buffer_load_dwordx4 v[100:103], v30, s[32:35], s39 offen sc1
    ds_read_b64_tr_b16 a[32:33], v8 offset:6144
    ds_read_b64_tr_b16 a[34:35], v8 offset:7168
    v_mfma_f32_32x32x16_bf16 v[192:207], a[220:223], v[76:79], v[192:207]
    ds_read_b64_tr_b16 a[36:37], v9 offset:6144
    ds_read_b64_tr_b16 a[38:39], v9 offset:7168
    s_waitcnt vmcnt(5)
    v_mfma_f32_32x32x16_bf16 v[176:191], a[224:227], v[80:83], v[176:191]
    buffer_load_dwordx4 v[104:107], v30, s[32:35], s40 offen sc1
    ds_read_b64_tr_b16 a[40:41], v8 offset:8192
    ds_read_b64_tr_b16 a[42:43], v8 offset:9216
    v_mfma_f32_32x32x16_bf16 v[192:207], a[228:231], v[80:83], v[192:207]
    ds_read_b64_tr_b16 a[44:45], v9 offset:8192
    ds_read_b64_tr_b16 a[46:47], v9 offset:9216
    s_waitcnt vmcnt(5)
    v_mfma_f32_32x32x16_bf16 v[176:191], a[232:235], v[84:87], v[176:191]
    buffer_load_dwordx4 v[108:111], v30, s[32:35], s41 offen sc1
    ds_read_b64_tr_b16 a[48:49], v8 offset:0
    ds_read_b64_tr_b16 a[50:51], v8 offset:1024
    v_mfma_f32_32x32x16_bf16 v[192:207], a[236:239], v[84:87], v[192:207]
    ds_read_b64_tr_b16 a[52:53], v9 offset:0
    ds_read_b64_tr_b16 a[54:55], v9 offset:1024
    s_waitcnt vmcnt(5)
    v_mfma_f32_32x32x16_bf16 v[208:223], a[0:3], v[88:91], v[208:223]
    buffer_load_dwordx4 v[112:115], v30, s[32:35], s42 offen sc1
    ds_read_b64_tr_b16 a[56:57], v8 offset:2048
    ds_read_b64_tr_b16 a[58:59], v8 offset:3072
    ds_read_b64_tr_b16 a[60:61], v9 offset:2048
    ds_read_b64_tr_b16 a[62:63], v9 offset:3072
    v_lshlrev_b32 v170, 16, v240
    v_mfma_f32_32x32x16_bf16 v[224:239], a[4:7], v[88:91], v[224:239]
    v_and_b32 v171, 0xffff0000, v240
    v_lshlrev_b32 v172, 16, v248
    v_and_b32 v173, 0xffff0000, v248
    v_add_f32 v152, v170, v172
    s_waitcnt vmcnt(5)
    v_mfma_f32_32x32x16_bf16 v[208:223], a[8:11], v[92:95], v[208:223]
    buffer_load_dwordx4 v[116:119], v31, s[32:35], s36 offen sc1
    ds_read_b64_tr_b16 a[64:65], v5 offset:0
    ds_read_b64_tr_b16 a[66:67], v5 offset:1024
    ds_read_b64_tr_b16 a[68:69], v14 offset:0
    ds_read_b64_tr_b16 a[70:71], v14 offset:1024
    v_add_f32 v153, v171, v173
    v_mfma_f32_32x32x16_bf16 v[224:239], a[12:15], v[92:95], v[224:239]
    v_lshlrev_b32 v170, 16, v241
    v_and_b32 v171, 0xffff0000, v241
    v_lshlrev_b32 v172, 16, v249
    v_and_b32 v173, 0xffff0000, v249
    s_waitcnt vmcnt(5) lgkmcnt(15)
    v_mfma_f32_32x32x16_bf16 v[208:223], a[16:19], v[96:99], v[208:223]
    buffer_load_dwordx4 v[72:75], v31, s[32:35], s37 offen sc1
    ds_read_b64_tr_b16 a[72:73], v5 offset:2048
    ds_read_b64_tr_b16 a[74:75], v5 offset:3072
    ds_read_b64_tr_b16 a[76:77], v14 offset:2048
    ds_read_b64_tr_b16 a[78:79], v14 offset:3072
    v_add_f32 v154, v170, v172
    v_mfma_f32_32x32x16_bf16 v[224:239], a[20:23], v[96:99], v[224:239]
    v_add_f32 v155, v171, v173
    v_lshlrev_b32 v170, 16, v242
    v_and_b32 v171, 0xffff0000, v242
    v_lshlrev_b32 v172, 16, v250
    s_waitcnt vmcnt(5)
    v_mfma_f32_32x32x16_bf16 v[208:223], a[24:27], v[100:103], v[208:223]
    buffer_load_dwordx4 v[76:79], v31, s[32:35], s38 offen sc1
    ds_read_b64_tr_b16 a[80:81], v5 offset:4096
    ds_read_b64_tr_b16 a[82:83], v5 offset:5120
    ds_read_b64_tr_b16 a[84:85], v14 offset:4096
    ds_read_b64_tr_b16 a[86:87], v14 offset:5120
    v_and_b32 v173, 0xffff0000, v250
    v_mfma_f32_32x32x16_bf16 v[224:239], a[28:31], v[100:103], v[224:239]
    v_add_f32 v156, v170, v172
    v_add_f32 v157, v171, v173
    v_lshlrev_b32 v170, 16, v243
    v_and_b32 v171, 0xffff0000, v243
    s_waitcnt vmcnt(5)
    v_mfma_f32_32x32x16_bf16 v[208:223], a[32:35], v[104:107], v[208:223]
    buffer_load_dwordx4 v[80:83], v31, s[32:35], s39 offen sc1
    ds_read_b64_tr_b16 a[88:89], v5 offset:6144
    ds_read_b64_tr_b16 a[90:91], v5 offset:7168
    ds_read_b64_tr_b16 a[92:93], v14 offset:6144
    ds_read_b64_tr_b16 a[94:95], v14 offset:7168
    v_lshlrev_b32 v172, 16, v251
    v_mfma_f32_32x32x16_bf16 v[224:239], a[36:39], v[104:107], v[224:239]
    v_and_b32 v173, 0xffff0000, v251
    v_add_f32 v158, v170, v172
    v_add_f32 v159, v171, v173
    v_lshlrev_b32 v170, 16, v244
    s_waitcnt vmcnt(5) lgkmcnt(15)
    v_mfma_f32_32x32x16_bf16 v[208:223], a[40:43], v[108:111], v[208:223]
    buffer_load_dwordx4 v[84:87], v31, s[32:35], s40 offen sc1
    ds_read_b64_tr_b16 a[96:97], v5 offset:8192
    ds_read_b64_tr_b16 a[98:99], v5 offset:9216
    ds_read_b64_tr_b16 a[100:101], v14 offset:8192
    ds_read_b64_tr_b16 a[102:103], v14 offset:9216
    v_and_b32 v171, 0xffff0000, v244
    v_mfma_f32_32x32x16_bf16 v[224:239], a[44:47], v[108:111], v[224:239]
    v_lshlrev_b32 v172, 16, v252
    v_and_b32 v173, 0xffff0000, v252
    v_add_f32 v160, v170, v172
    v_add_f32 v161, v171, v173
    s_waitcnt vmcnt(5)
    v_mfma_f32_32x32x16_bf16 v[208:223], a[48:51], v[112:115], v[208:223]
    buffer_load_dwordx4 v[88:91], v31, s[32:35], s41 offen sc1
    ds_read_b64_tr_b16 a[104:105], v5 offset:10240
    ds_read_b64_tr_b16 a[106:107], v5 offset:11264
    ds_read_b64_tr_b16 a[108:109], v14 offset:10240
    ds_read_b64_tr_b16 a[110:111], v14 offset:11264
    v_lshlrev_b32 v170, 16, v245
    v_mfma_f32_32x32x16_bf16 v[224:239], a[52:55], v[112:115], v[224:239]
    v_and_b32 v171, 0xffff0000, v245
    v_lshlrev_b32 v172, 16, v253
    v_and_b32 v173, 0xffff0000, v253
    v_add_f32 v162, v170, v172
    s_waitcnt vmcnt(5)
    v_mfma_f32_32x32x16_bf16 v[208:223], a[56:59], v[116:119], v[208:223]
    buffer_load_dwordx4 v[92:95], v31, s[32:35], s42 offen sc1
    v_add_f32 v163, v171, v173
    v_lshlrev_b32 v170, 16, v246
    v_mfma_f32_32x32x16_bf16 v[224:239], a[60:63], v[116:119], v[224:239]
    v_and_b32 v171, 0xffff0000, v246
    v_lshlrev_b32 v172, 16, v254
    v_and_b32 v173, 0xffff0000, v254
    s_waitcnt vmcnt(5) lgkmcnt(15)
    v_mfma_f32_32x32x16_bf16 v[208:223], a[64:67], v[72:75], v[208:223]
    buffer_load_dwordx4 v[96:99], v26, s[32:35], s36 offen sc1
    v_add_f32 v164, v170, v172
    v_add_f32 v165, v171, v173
    v_mfma_f32_32x32x16_bf16 v[224:239], a[68:71], v[72:75], v[224:239]
    v_lshlrev_b32 v170, 16, v247
    v_and_b32 v171, 0xffff0000, v247
    v_lshlrev_b32 v172, 16, v255
    s_waitcnt vmcnt(5)
    v_mfma_f32_32x32x16_bf16 v[208:223], a[72:75], v[76:79], v[208:223]
    buffer_load_dwordx4 v[100:103], v26, s[32:35], s37 offen sc1
    v_and_b32 v173, 0xffff0000, v255
    v_add_f32 v166, v170, v172
    v_mfma_f32_32x32x16_bf16 v[224:239], a[76:79], v[76:79], v[224:239]
    v_add_f32 v167, v171, v173
    s_and_b32 s3, s6, 1
    s_lshl_b32 s3, s3, 2
    v_lshrrev_b32 v170, 5, v1
    s_waitcnt vmcnt(5) lgkmcnt(14)
    v_mfma_f32_32x32x16_bf16 v[208:223], a[80:83], v[80:83], v[208:223]
    buffer_load_dwordx4 v[104:107], v26, s[32:35], s38 offen sc1
    v_or_b32 v170, s3, v170
    v_and_b32 v171, 7, v1
    s_waitcnt lgkmcnt(12)
    v_mfma_f32_32x32x16_bf16 v[224:239], a[84:87], v[80:83], v[224:239]
    v_xor_b32 v170, v170, v171
    v_and_b32 v171, 31, v1
    s_lshr_b32 s54, s6, 1
    s_lshl_b32 s54, s54, 12
    s_add_u32 s54, s54, 106496
    s_waitcnt vmcnt(5) lgkmcnt(10)
    v_mfma_f32_32x32x16_bf16 v[208:223], a[88:91], v[84:87], v[208:223]
    buffer_load_dwordx4 v[108:111], v26, s[32:35], s39 offen sc1
    v_lshl_add_u32 v171, v171, 7, s54
    v_lshl_add_u32 v56, v170, 4, v171
    s_waitcnt lgkmcnt(8)
    v_mfma_f32_32x32x16_bf16 v[224:239], a[92:95], v[84:87], v[224:239]
    v_xor_b32 v58, 32, v56
    v_lshrrev_b32 v170, 3, v1
    v_and_b32 v171, 7, v1
    s_waitcnt vmcnt(5) lgkmcnt(6)
    v_mfma_f32_32x32x16_bf16 v[208:223], a[96:99], v[88:91], v[208:223]
    buffer_load_dwordx4 v[112:115], v26, s[32:35], s40 offen sc1
    v_xor_b32 v172, v170, v171
    s_lshl_b32 s3, s3, 2
    s_waitcnt lgkmcnt(4)
    v_mfma_f32_32x32x16_bf16 v[224:239], a[100:103], v[88:91], v[224:239]
    v_add_u32 v170, s3, v170
    v_lshl_add_u32 v173, v170, 7, s54
    v_lshl_add_u32 v57, v172, 4, v173
    s_waitcnt vmcnt(5) lgkmcnt(2)
    v_mfma_f32_32x32x16_bf16 v[208:223], a[104:107], v[92:95], v[208:223]
    buffer_load_dwordx4 v[116:119], v26, s[32:35], s41 offen sc1
    v_mul_u32_u24 v170, 896, v170
    v_lshl_add_u32 v11, v171, 4, v170
    s_waitcnt lgkmcnt(0)
    v_mfma_f32_32x32x16_bf16 v[224:239], a[108:111], v[92:95], v[224:239]
    s_and_b32 s78, s78, -128
    s_add_u32 s55, s78, 7168
    s_waitcnt vmcnt(5)
    v_mfma_f32_32x32x16_bf16 v[176:191], a[0:3], v[96:99], v[176:191]
    buffer_load_dwordx4 v[72:75], v26, s[32:35], s42 offen sc1
    s_nop 1
    ds_write_b128 v21, v[208:211] offset:0
    v_mfma_f32_32x32x16_bf16 v[192:207], a[4:7], v[96:99], v[192:207]
    ds_write_b128 v21, v[212:215] offset:1024
    s_waitcnt vmcnt(5)
    v_mfma_f32_32x32x16_bf16 v[176:191], a[8:11], v[100:103], v[176:191]
    buffer_load_dwordx4 v[76:79], v27, s[32:35], s36 offen sc1
    v_mfma_f32_32x32x16_bf16 v[192:207], a[12:15], v[100:103], v[192:207]
    ds_write_b128 v21, v[216:219] offset:2048
    s_waitcnt vmcnt(5)
    v_mfma_f32_32x32x16_bf16 v[176:191], a[16:19], v[104:107], v[176:191]
    buffer_load_dwordx4 v[80:83], v27, s[32:35], s37 offen sc1
    v_mfma_f32_32x32x16_bf16 v[192:207], a[20:23], v[104:107], v[192:207]
    ds_write_b128 v21, v[220:223] offset:3072
    s_waitcnt vmcnt(5)
    v_mfma_f32_32x32x16_bf16 v[176:191], a[24:27], v[108:111], v[176:191]
    buffer_load_dwordx4 v[84:87], v27, s[32:35], s38 offen sc1
    ds_write_b128 v22, v[224:227] offset:0
    v_mfma_f32_32x32x16_bf16 v[192:207], a[28:31], v[108:111], v[192:207]
    ds_write_b128 v22, v[228:231] offset:1024
    s_waitcnt vmcnt(5)
    v_mfma_f32_32x32x16_bf16 v[176:191], a[32:35], v[112:115], v[176:191]
    buffer_load_dwordx4 v[88:91], v27, s[32:35], s39 offen sc1
    v_mfma_f32_32x32x16_bf16 v[192:207], a[36:39], v[112:115], v[192:207]
    ds_write_b128 v22, v[232:235] offset:2048
    s_waitcnt vmcnt(5)
    v_mfma_f32_32x32x16_bf16 v[176:191], a[40:43], v[116:119], v[176:191]
    buffer_load_dwordx4 v[92:95], v27, s[32:35], s40 offen sc1
    v_mfma_f32_32x32x16_bf16 v[192:207], a[44:47], v[116:119], v[192:207]
    ds_write_b128 v22, v[236:239] offset:3072
    s_waitcnt vmcnt(5)
    v_mfma_f32_32x32x16_bf16 v[176:191], a[48:51], v[72:75], v[176:191]
    buffer_load_dwordx4 v[96:99], v27, s[32:35], s41 offen sc1
    s_waitcnt lgkmcnt(0)
    s_barrier
    ds_read_b128 v[120:123], v23 offset:4096
    v_mfma_f32_32x32x16_bf16 v[192:207], a[52:55], v[72:75], v[192:207]
    ds_read_b128 v[136:139], v23 offset:8192
    ds_read_b128 v[124:127], v23 offset:5120
    ds_read_b128 v[140:143], v23 offset:9216
    s_waitcnt vmcnt(5)
    v_mfma_f32_32x32x16_bf16 v[176:191], a[56:59], v[76:79], v[176:191]
    buffer_load_dwordx4 v[100:103], v27, s[32:35], s42 offen sc1
    ds_read_b128 v[128:131], v23 offset:6144
    ds_read_b128 v[144:147], v23 offset:10240
    v_mfma_f32_32x32x16_bf16 v[192:207], a[60:63], v[76:79], v[192:207]
    ds_read_b128 v[132:135], v23 offset:7168
    ds_read_b128 v[148:151], v23 offset:11264
    s_waitcnt vmcnt(5)
    v_mfma_f32_32x32x16_bf16 v[176:191], a[64:67], v[80:83], v[176:191]
    s_waitcnt lgkmcnt(6)
    v_add_f32 v120, v120, v136
    v_add_f32 v121, v121, v137
    v_add_f32 v122, v122, v138
    v_add_f32 v123, v123, v139
    s_waitcnt lgkmcnt(4)
    v_add_f32 v124, v124, v140
    v_add_f32 v125, v125, v141
    v_add_f32 v126, v126, v142
    v_add_f32 v127, v127, v143
    v_mfma_f32_32x32x16_bf16 v[192:207], a[68:71], v[80:83], v[192:207]
    s_waitcnt lgkmcnt(2)
    v_add_f32 v128, v128, v144
    v_add_f32 v129, v129, v145
    v_add_f32 v130, v130, v146
    v_add_f32 v131, v131, v147
    s_waitcnt lgkmcnt(0)
    v_add_f32 v132, v132, v148
    v_add_f32 v133, v133, v149
    v_add_f32 v134, v134, v150
    v_add_f32 v135, v135, v151
    s_waitcnt vmcnt(4)
    v_mfma_f32_32x32x16_bf16 v[192:207], a[76:79], v[84:87], v[192:207]
    v_fmac_f32 v152, v120, v168
    v_fmac_f32 v153, v121, v168
    v_fmac_f32 v154, v122, v168
    v_fmac_f32 v155, v123, v168
    s_waitcnt vmcnt(3)
    v_mfma_f32_32x32x16_bf16 v[192:207], a[84:87], v[88:91], v[192:207]
    v_fmac_f32 v156, v124, v168
    v_fmac_f32 v157, v125, v168
    v_fmac_f32 v158, v126, v168
    s_waitcnt vmcnt(2)
    v_mfma_f32_32x32x16_bf16 v[192:207], a[92:95], v[92:95], v[192:207]
    v_fmac_f32 v159, v127, v168
    v_fmac_f32 v160, v128, v168
    v_fmac_f32 v161, v129, v168
    s_waitcnt vmcnt(1)
    v_mfma_f32_32x32x16_bf16 v[192:207], a[100:103], v[96:99], v[192:207]
    v_fmac_f32 v162, v130, v168
    v_fmac_f32 v163, v131, v168
    v_fmac_f32 v164, v132, v168
    s_waitcnt vmcnt(0)
    v_mfma_f32_32x32x16_bf16 v[192:207], a[108:111], v[100:103], v[192:207]
    v_fmac_f32 v165, v133, v168
    v_fmac_f32 v166, v134, v168
    v_fmac_f32 v167, v135, v168
    v_mfma_f32_32x32x16_bf16 v[176:191], a[72:75], v[84:87], v[176:191]
    s_lshl_b32 s3, s2, 2
    s_add_u32 s3, s3, s6
    s_cmp_eq_u32 s3, 0
    s_cselect_b32 s3, 0, 1073741824
    v_mov_b32 v39, s59
    s_mov_b64 exec, 1
    buffer_store_dword v39, off, s[32:35], s3 sc1
    s_mov_b64 exec, -1
    v_mfma_f32_32x32x16_bf16 v[176:191], a[80:83], v[88:91], v[176:191]
    ds_write_b128 v20, v[192:195] offset:0
    v_mfma_f32_32x32x16_bf16 v[176:191], a[88:91], v[92:95], v[176:191]
    ds_write_b128 v20, v[196:199] offset:1024
    v_mfma_f32_32x32x16_bf16 v[176:191], a[96:99], v[96:99], v[176:191]
    ds_write_b128 v20, v[200:203] offset:2048
    v_mfma_f32_32x32x16_bf16 v[176:191], a[104:107], v[100:103], v[176:191]
    ds_write_b128 v20, v[204:207] offset:3072
    s_waitcnt lgkmcnt(0)
    s_barrier
    ds_read_b128 v[120:123], v23 offset:0
    ds_read_b128 v[124:127], v23 offset:1024
    ds_read_b128 v[128:131], v23 offset:2048
    ds_read_b128 v[132:135], v23 offset:3072
    s_nop 4
    v_pk_fma_f32 v[152:153], v[176:177], v[168:169], v[152:153] op_sel_hi:[1,0,1]
    v_pk_fma_f32 v[154:155], v[178:179], v[168:169], v[154:155] op_sel_hi:[1,0,1]
    v_pk_fma_f32 v[156:157], v[180:181], v[168:169], v[156:157] op_sel_hi:[1,0,1]
    v_pk_fma_f32 v[158:159], v[182:183], v[168:169], v[158:159] op_sel_hi:[1,0,1]
    v_pk_fma_f32 v[160:161], v[184:185], v[168:169], v[160:161] op_sel_hi:[1,0,1]
    v_pk_fma_f32 v[162:163], v[186:187], v[168:169], v[162:163] op_sel_hi:[1,0,1]
    v_pk_fma_f32 v[164:165], v[188:189], v[168:169], v[164:165] op_sel_hi:[1,0,1]
    v_pk_fma_f32 v[166:167], v[190:191], v[168:169], v[166:167] op_sel_hi:[1,0,1]
    s_waitcnt lgkmcnt(3)
    v_pk_fma_f32 v[152:153], v[120:121], v[168:169], v[152:153] op_sel_hi:[1,0,1]
    v_pk_fma_f32 v[154:155], v[122:123], v[168:169], v[154:155] op_sel_hi:[1,0,1]
    s_waitcnt lgkmcnt(2)
    v_pk_fma_f32 v[156:157], v[124:125], v[168:169], v[156:157] op_sel_hi:[1,0,1]
    v_pk_fma_f32 v[158:159], v[126:127], v[168:169], v[158:159] op_sel_hi:[1,0,1]
    v_cvt_pk_bf16_f32 v136, v152, v153
    v_cvt_pk_bf16_f32 v137, v154, v155
    v_cvt_pk_bf16_f32 v138, v156, v157
    v_cvt_pk_bf16_f32 v139, v158, v159
    s_nop 0
    v_permlane32_swap_b32 v136, v138
    v_permlane32_swap_b32 v137, v139
    ds_write_b128 v56, v[136:139]
    s_waitcnt lgkmcnt(2)
    v_pk_fma_f32 v[160:161], v[128:129], v[168:169], v[160:161] op_sel_hi:[1,0,1]
    v_pk_fma_f32 v[162:163], v[130:131], v[168:169], v[162:163] op_sel_hi:[1,0,1]
    s_waitcnt lgkmcnt(1)
    v_pk_fma_f32 v[164:165], v[132:133], v[168:169], v[164:165] op_sel_hi:[1,0,1]
    v_pk_fma_f32 v[166:167], v[134:135], v[168:169], v[166:167] op_sel_hi:[1,0,1]
    v_cvt_pk_bf16_f32 v140, v160, v161
    v_cvt_pk_bf16_f32 v141, v162, v163
    v_cvt_pk_bf16_f32 v142, v164, v165
    v_cvt_pk_bf16_f32 v143, v166, v167
    s_nop 0
    v_permlane32_swap_b32 v140, v142
    v_permlane32_swap_b32 v141, v143
    ds_write_b128 v58, v[140:143]
    s_waitcnt lgkmcnt(0)
    s_barrier
    ds_read_b128 v[120:123], v57 offset:0
    ds_read_b128 v[124:127], v57 offset:1024
    s_waitcnt lgkmcnt(1)
    buffer_store_dwordx4 v[120:123], v11, s[28:31], s78 offen nt
    s_waitcnt lgkmcnt(0)
    buffer_store_dwordx4 v[124:127], v11, s[28:31], s55 offen nt
    s_endpgm
.section .rodata,"a"
.p2align 6
.amdhsa_kernel sequential_preLN__linear_attn_block__dense_activation_squared_relu__prompt_kernel
  .amdhsa_next_free_vgpr 512
  .amdhsa_next_free_sgpr 102
  .amdhsa_accum_offset 256
  .amdhsa_group_segment_fixed_size 0
  .amdhsa_kernarg_size 88
  .amdhsa_user_sgpr_count 2
  .amdhsa_user_sgpr_kernarg_segment_ptr 1
  .amdhsa_system_sgpr_workgroup_id_x 1
.end_amdhsa_kernel
```
